```python
import torch

def _softmax(x, axis=-1):
    return torch.softmax(x, dim=axis)
def _gelu(x):
    return torch.nn.functional.gelu(x, approximate="tanh")
def _silu(x):
    return torch.nn.functional.silu(x)
def _sigmoid(x):
    return torch.sigmoid(x)
def _layernorm(x, axis=-1, eps=1e-5):
    m = x.mean(dim=axis, keepdim=True)
    v = x.var(dim=axis, keepdim=True, unbiased=False)
    return (x - m) / torch.sqrt(v + eps)
def _scatter_add(tgt, idx, src, axis=0):
    return tgt.clone().index_add_(axis, idx, src)
def _segment_sum(src, seg, n):
    out = torch.zeros((n,) + src.shape[1:], dtype=src.dtype)
    return out.index_add_(0, seg, src)
def _pad(x, pw):
    flat = tuple(v for pair in reversed(pw) for v in pair)
    return torch.nn.functional.pad(x, flat)

kernel_name = 'recurrent_scan__linear_attn_block__glu_gated_swiglu__prompt'

def setup_inputs():

    _w = (lambda a: (lambda t: t.to(torch.bfloat16) if t.is_floating_point() else t)(torch.as_tensor(a)))
    def _A_setup():
        B, S, D = 1, 2048, 448
        return {
            "x": _w((lambda *s: torch.randn(*s, dtype=torch.bfloat16) * 0.05)(B, S, D)),
            "wqkv": _w((lambda *s: torch.randn(*s, dtype=torch.bfloat16) * 0.8)(D, 3 * D)),
            "wo": _w((lambda *s: torch.randn(*s, dtype=torch.bfloat16) * 0.8)(D, D)),
        }
    _A_in = _A_setup()

    def _B_setup():
        B, S, D, F = 1, 2048, 448, 1792
        return {
            "x": _w((lambda *s: torch.randn(*s, dtype=torch.bfloat16) * 0.05)(B, S, D)),
            "w1": _w((lambda *s: torch.randn(*s, dtype=torch.bfloat16) * 0.2)(D, F) * (2.0 / D) ** 0.5),
            "w3": _w((lambda *s: torch.randn(*s, dtype=torch.bfloat16) * 0.2)(D, F) * (2.0 / D) ** 0.5),
            "w2": _w((lambda *s: torch.randn(*s, dtype=torch.bfloat16) * 0.2)(F, D) * (2.0 / F) ** 0.5),
        }
    _B_in = _B_setup()

    return {
        "A_x": _A_in["x"],
        "A_wqkv": _A_in["wqkv"],
        "A_wo": _A_in["wo"],
        "B_x": _B_in["x"],
        "B_w1": _B_in["w1"],
        "B_w3": _B_in["w3"],
        "B_w2": _B_in["w2"],
    }

def reference(A_x, A_wqkv, A_wo, B_x, B_w1, B_w3, B_w2):
    def _A_ref(x, wqkv, wo):
        B, S, D = x.shape
        H = 16; Dh = D // H
        qkv = (lambda x, *d: x.permute(*d))((x @ wqkv).reshape(B, S, 3, H, Dh), 2, 0, 3, 1, 4)
        q, k, v = qkv[0], qkv[1], qkv[2]
        phi = lambda t: torch.where(t > 0, t + 1, torch.exp(t)) + 1e-6
        pq, pk = phi(q), phi(k)
        kv = torch.einsum("bhsd,bhse->bhde", pk, v)
        z = torch.einsum("bhsd->bhd", pk)
        num = torch.einsum("bhqd,bhde->bhqe", pq, kv)
        den = torch.einsum("bhqd,bhd->bhq", pq, z)[..., None] + 1e-6
        o = num / den
        return (lambda x, *d: x.permute(*d))(o, 0, 2, 1, 3).reshape(B, S, D) @ wo

    def _B_ref(x, w1, w3, w2):
        gate = torch.einsum("bsd,df->bsf", x, w1)
        up = torch.einsum("bsd,df->bsf", x, w3)
        h = _silu(gate) * up
        out = torch.einsum("bsf,fd->bsd", h, w2)
        return out

    x = A_x
    xn = _layernorm(x, axis=-1)
    s = _A_ref(xn, A_wqkv, A_wo)
    g = _silu(_B_ref(xn, B_w1, B_w3, B_w2))
    return x + s * g
```

```asm
; @launch kernel=k0_kernel grid=(2248,1,1) block=(256,1,1) lds=0
; @launch kernel=k1_kernel grid=(256,1,1) block=(512,1,1) lds=90112
; @launch kernel=k2_kernel grid=(224,1,1) block=(512,1,1) lds=131072
.amdgcn_target "amdgcn-amd-amdhsa--gfx950"
.text
.globl k0_kernel
.p2align 8
.type k0_kernel,@function
k0_kernel:
    s_cmp_ge_u32 s2, 2248
    s_cbranch_scc1 K0_done
    s_cmp_ge_u32 s2, 512
    s_cbranch_scc1 K0_rep
    s_load_dwordx2 s[8:9], s[0:1], 0
    s_load_dwordx2 s[24:25], s[0:1], 72
    v_and_b32 v1, 63, v0
    v_lshrrev_b32 v2, 6, v0
    s_nop 0
    v_readfirstlane_b32 s6, v2
    s_waitcnt lgkmcnt(0)
    s_and_b32 s9, s9, 0xffff
    s_mov_b32 s10, 1835008
    s_mov_b32 s11, 0x20000
    s_and_b32 s25, s25, 0xffff
    s_mov_b32 s26, 67108864
    s_mov_b32 s27, 0x20000
    s_lshl_b32 s4, s2, 2
    s_add_u32 s4, s4, s6
    s_mul_i32 s5, s4, 896
    v_lshlrev_b32 v3, 4, v1
    v_cmp_gt_u32 s[32:33], 56, v1
    v_min_u32 v3, 880, v3
    buffer_load_dwordx4 v[4:7], v3, s[8:11], s5 offen
    s_waitcnt vmcnt(0)
    v_cndmask_b32 v4, 0, v4, s[32:33]
    v_cndmask_b32 v5, 0, v5, s[32:33]
    v_cndmask_b32 v6, 0, v6, s[32:33]
    v_cndmask_b32 v7, 0, v7, s[32:33]
    v_lshlrev_b32 v8, 16, v4
    v_and_b32 v9, 0xffff0000, v4
    v_lshlrev_b32 v10, 16, v5
    v_and_b32 v11, 0xffff0000, v5
    v_lshlrev_b32 v12, 16, v6
    v_and_b32 v13, 0xffff0000, v6
    v_lshlrev_b32 v14, 16, v7
    v_and_b32 v15, 0xffff0000, v7
    v_lshlrev_b32 v21, 2, v1
    v_xor_b32 v21, 128, v21
    v_pk_add_f32 v[16:17], v[8:9], v[10:11]
    v_pk_add_f32 v[18:19], v[12:13], v[14:15]
    v_pk_add_f32 v[16:17], v[16:17], v[18:19]
    v_add_f32 v16, v16, v17
    ds_swizzle_b32 v20, v16 offset:1055
    s_waitcnt lgkmcnt(0)
    v_add_f32 v16, v16, v20
    ds_swizzle_b32 v20, v16 offset:2079
    s_waitcnt lgkmcnt(0)
    v_add_f32 v16, v16, v20
    ds_swizzle_b32 v20, v16 offset:4127
    s_waitcnt lgkmcnt(0)
    v_add_f32 v16, v16, v20
    ds_swizzle_b32 v20, v16 offset:8223
    s_waitcnt lgkmcnt(0)
    v_add_f32 v16, v16, v20
    ds_swizzle_b32 v20, v16 offset:16415
    s_waitcnt lgkmcnt(0)
    v_add_f32 v16, v16, v20
    ds_bpermute_b32 v20, v21, v16
    s_waitcnt lgkmcnt(0)
    v_add_f32 v16, v16, v20
    v_mul_f32 v16, 0x3b124925, v16
    v_mov_b32 v17, v16
    v_pk_add_f32 v[24:25], v[8:9], v[16:17] neg_lo:[0,1] neg_hi:[0,1]
    v_pk_add_f32 v[26:27], v[10:11], v[16:17] neg_lo:[0,1] neg_hi:[0,1]
    v_pk_add_f32 v[28:29], v[12:13], v[16:17] neg_lo:[0,1] neg_hi:[0,1]
    v_pk_add_f32 v[30:31], v[14:15], v[16:17] neg_lo:[0,1] neg_hi:[0,1]
    v_pk_mul_f32 v[18:19], v[24:25], v[24:25]
    v_pk_fma_f32 v[18:19], v[26:27], v[26:27], v[18:19]
    v_pk_fma_f32 v[18:19], v[28:29], v[28:29], v[18:19]
    v_pk_fma_f32 v[18:19], v[30:31], v[30:31], v[18:19]
    v_add_f32 v18, v18, v19
    v_cndmask_b32 v18, 0, v18, s[32:33]
    ds_swizzle_b32 v20, v18 offset:1055
    s_waitcnt lgkmcnt(0)
    v_add_f32 v18, v18, v20
    ds_swizzle_b32 v20, v18 offset:2079
    s_waitcnt lgkmcnt(0)
    v_add_f32 v18, v18, v20
    ds_swizzle_b32 v20, v18 offset:4127
    s_waitcnt lgkmcnt(0)
    v_add_f32 v18, v18, v20
    ds_swizzle_b32 v20, v18 offset:8223
    s_waitcnt lgkmcnt(0)
    v_add_f32 v18, v18, v20
    ds_swizzle_b32 v20, v18 offset:16415
    s_waitcnt lgkmcnt(0)
    v_add_f32 v18, v18, v20
    ds_bpermute_b32 v20, v21, v18
    s_waitcnt lgkmcnt(0)
    v_add_f32 v18, v18, v20
    v_mul_f32 v18, 0x3b124925, v18
    v_cvt_pk_bf16_f32 v22, v18, v16
    v_lshlrev_b32 v18, 16, v22
    v_and_b32 v16, 0xffff0000, v22
    v_add_f32 v18, 0x3727c5ac, v18
    v_cvt_pk_bf16_f32 v22, v18, v19
    v_lshlrev_b32 v18, 16, v22
    v_and_b32 v19, 0xffff0000, v22
    v_sqrt_f32 v18, v18
    s_nop 0
    v_cvt_pk_bf16_f32 v22, v18, v19
    v_lshlrev_b32 v18, 16, v22
    v_and_b32 v19, 0xffff0000, v22
    v_rcp_f32 v18, v18
    s_nop 0
    v_mov_b32 v19, v18
    v_mov_b32 v17, v16
    v_pk_add_f32 v[8:9], v[8:9], v[16:17] neg_lo:[0,1] neg_hi:[0,1]
    v_cvt_pk_bf16_f32 v4, v8, v9
    v_lshlrev_b32 v8, 16, v4
    v_and_b32 v9, 0xffff0000, v4
    v_pk_mul_f32 v[8:9], v[8:9], v[18:19]
    v_cvt_pk_bf16_f32 v4, v8, v9
    v_pk_add_f32 v[10:11], v[10:11], v[16:17] neg_lo:[0,1] neg_hi:[0,1]
    v_cvt_pk_bf16_f32 v5, v10, v11
    v_lshlrev_b32 v10, 16, v5
    v_and_b32 v11, 0xffff0000, v5
    v_pk_mul_f32 v[10:11], v[10:11], v[18:19]
    v_cvt_pk_bf16_f32 v5, v10, v11
    v_pk_add_f32 v[12:13], v[12:13], v[16:17] neg_lo:[0,1] neg_hi:[0,1]
    v_cvt_pk_bf16_f32 v6, v12, v13
    v_lshlrev_b32 v12, 16, v6
    v_and_b32 v13, 0xffff0000, v6
    v_pk_mul_f32 v[12:13], v[12:13], v[18:19]
    v_cvt_pk_bf16_f32 v6, v12, v13
    v_pk_add_f32 v[14:15], v[14:15], v[16:17] neg_lo:[0,1] neg_hi:[0,1]
    v_cvt_pk_bf16_f32 v7, v14, v15
    v_lshlrev_b32 v14, 16, v7
    v_and_b32 v15, 0xffff0000, v7
    v_pk_mul_f32 v[14:15], v[14:15], v[18:19]
    v_cvt_pk_bf16_f32 v7, v14, v15
    v_lshrrev_b32 v3, 1, v1
    v_lshlrev_b32 v3, 10, v3
    v_and_b32 v2, 1, v1
    v_lshl_add_u32 v3, v2, 9, v3
    s_lshr_b32 s30, s4, 5
    s_mul_i32 s30, s30, 28672
    s_and_b32 s31, s4, 31
    s_lshl_b32 s31, s31, 4
    s_add_u32 s30, s30, s31
    s_add_u32 s30, s30, 14680064
    s_and_saveexec_b64 s[34:35], s[32:33]
    buffer_store_dwordx4 v[4:7], v3, s[24:27], s30 offen
    s_branch K0_done
K0_rep:
    s_load_dwordx2 s[24:25], s[0:1], 72
    v_bfe_u32 v2, v0, 2, 2
    v_and_b32 v3, 3, v0
    s_cmp_ge_u32 s2, 1744
    s_cbranch_scc1 K0_w2
    s_sub_u32 s4, s2, 512
    s_mul_hi_u32 s5, s4, 0x24924925
    s_mul_i32 s6, s5, 7
    s_sub_u32 s6, s4, s6
    s_lshl_b32 s7, s6, 4
    v_lshrrev_b32 v4, 4, v0
    v_add_u32 v4, s7, v4
    v_lshl_add_u32 v4, v4, 2, v2
    s_mul_i32 s30, s5, 28672
    s_lshl_b32 s31, s6, 12
    s_add_u32 s30, s30, s31
    v_lshlrev_b32 v5, 4, v0
    s_cmp_ge_u32 s5, 128
    s_cbranch_scc1 K0_wq
    s_and_b32 s31, s5, 1
    s_lshl_b32 s31, s31, 3
    s_add_u32 s31, s31, 32
    s_load_dwordx2 s[8:9], s[0:1], s31
    s_waitcnt lgkmcnt(0)
    s_and_b32 s9, s9, 0xffff
    s_mov_b32 s10, 1605632
    s_mov_b32 s11, 0x20000
    s_and_b32 s25, s25, 0xffff
    s_mov_b32 s26, 67108864
    s_mov_b32 s27, 0x20000
    s_lshr_b32 s32, s5, 3
    s_mul_i32 s32, s32, 224
    s_bfe_u32 s33, s5, 0x20001
    s_lshl_b32 s33, s33, 6
    s_add_u32 s32, s32, s33
    s_movk_i32 s31, 3584
    v_mul_lo_u32 v4, v4, s31
    v_lshl_add_u32 v4, v3, 4, v4
    buffer_load_dwordx4 v[8:11], v4, s[8:11], s32 offen
    s_add_u32 s30, s30, 16777216
    s_waitcnt vmcnt(0)
    buffer_store_dwordx4 v[8:11], v5, s[24:27], s30 offen
    s_branch K0_done
K0_wq:
    s_load_dwordx2 s[8:9], s[0:1], 8
    s_waitcnt lgkmcnt(0)
    s_and_b32 s9, s9, 0xffff
    s_mov_b32 s10, 1204224
    s_mov_b32 s11, 0x20000
    s_and_b32 s25, s25, 0xffff
    s_mov_b32 s26, 67108864
    s_mov_b32 s27, 0x20000
    s_sub_u32 s5, s5, 128
    s_mul_hi_u32 s32, s5, 0x55555556
    s_mul_i32 s33, s32, 3
    s_sub_u32 s33, s5, s33
    s_mul_i32 s32, s32, 56
    s_mul_i32 s33, s33, 896
    s_add_u32 s32, s32, s33
    s_movk_i32 s31, 2688
    v_mul_lo_u32 v4, v4, s31
    v_lshl_add_u32 v4, v3, 4, v4
    buffer_load_dwordx2 v[8:9], v4, s[8:11], s32 offen
    buffer_load_dwordx2 v[10:11], v4, s[8:11], s32 offen offset:8
    s_add_u32 s30, s30, 17301504
    v_cmp_eq_u32 vcc, 3, v3
    s_waitcnt vmcnt(0)
    v_cndmask_b32 v10, v10, 0, vcc
    v_cndmask_b32 v11, v11, 0, vcc
    buffer_store_dwordx4 v[8:11], v5, s[24:27], s30 offen
    s_branch K0_done
K0_w2:
    v_bfe_u32 v4, v0, 4, 1
    v_lshlrev_b32 v4, 3, v4
    v_bfe_u32 v6, v0, 5, 1
    v_lshl_add_u32 v4, v6, 2, v4
    v_add_u32 v4, v4, v2
    v_lshrrev_b32 v6, 6, v0
    s_nop 0
    v_readfirstlane_b32 s6, v6
    v_lshlrev_b32 v5, 4, v0
    s_cmp_ge_u32 s2, 2136
    s_cbranch_scc1 K0_wo
    s_load_dwordx2 s[8:9], s[0:1], 48
    s_waitcnt lgkmcnt(0)
    s_and_b32 s9, s9, 0xffff
    s_mov_b32 s10, 1605632
    s_mov_b32 s11, 0x20000
    s_and_b32 s25, s25, 0xffff
    s_mov_b32 s26, 67108864
    s_mov_b32 s27, 0x20000
    s_sub_u32 s4, s2, 1744
    s_lshl_b32 s5, s4, 2
    s_add_u32 s5, s5, s6
    s_mul_hi_u32 s7, s5, 0x1249250
    s_mul_i32 s31, s7, 224
    s_sub_u32 s31, s5, s31
    s_lshr_b32 s32, s31, 1
    s_and_b32 s33, s31, 1
    s_mul_i32 s32, s32, 14336
    s_lshl_b32 s7, s7, 7
    s_lshl_b32 s33, s33, 6
    s_add_u32 s32, s32, s7
    s_add_u32 s32, s32, s33
    s_movk_i32 s31, 896
    v_mul_lo_u32 v4, v4, s31
    v_lshl_add_u32 v4, v3, 4, v4
    buffer_load_dwordx4 v[8:11], v4, s[8:11], s32 offen
    s_lshl_b32 s30, s4, 12
    s_add_u32 s30, s30, 23068672
    s_waitcnt vmcnt(0)
    buffer_store_dwordx4 v[8:11], v5, s[24:27], s30 offen
    s_branch K0_done
K0_wo:
    s_load_dwordx2 s[8:9], s[0:1], 16
    s_waitcnt lgkmcnt(0)
    s_and_b32 s9, s9, 0xffff
    s_mov_b32 s10, 401408
    s_mov_b32 s11, 0x20000
    s_and_b32 s25, s25, 0xffff
    s_mov_b32 s26, 67108864
    s_mov_b32 s27, 0x20000
    s_sub_u32 s4, s2, 2136
    s_lshl_b32 s5, s4, 2
    s_add_u32 s5, s5, s6
    s_lshr_b32 s7, s5, 5
    s_and_b32 s31, s5, 31
    s_lshr_b32 s32, s31, 1
    s_and_b32 s33, s31, 1
    s_lshl_b32 s33, s33, 4
    v_add_u32 v4, s33, v4
    v_min_u32 v4, 27, v4
    s_mul_i32 s32, s32, 25088
    s_lshl_b32 s7, s7, 6
    s_add_u32 s32, s32, s7
    s_movk_i32 s31, 896
    v_mul_lo_u32 v4, v4, s31
    v_lshl_add_u32 v4, v3, 4, v4
    buffer_load_dwordx4 v[8:11], v4, s[8:11], s32 offen
    s_lshl_b32 s30, s4, 12
    s_add_u32 s30, s30, 25165824
    s_waitcnt vmcnt(0)
    buffer_store_dwordx4 v[8:11], v5, s[24:27], s30 offen
K0_done:
    s_endpgm
.globl k1_kernel
.p2align 8
.type k1_kernel,@function
k1_kernel:
    s_cmp_ge_u32 s2, 256
    s_cbranch_scc1 K1_done
    s_load_dwordx2 s[12:13], s[0:1], 8
    s_load_dwordx2 s[16:17], s[0:1], 32
    s_load_dwordx2 s[20:21], s[0:1], 40
    s_load_dwordx2 s[24:25], s[0:1], 72
    s_mov_b32 s90, 1069066811
    s_mov_b32 s91, 897988541
    s_mov_b32 s92, 3216550459
    s_bfe_u32 s4, s2, 0x30004
    s_and_b32 s5, s2, 15
    v_and_b32 v1, 63, v0
    v_lshrrev_b32 v2, 6, v0
    s_nop 0
    v_readfirstlane_b32 s6, v2
    s_waitcnt lgkmcnt(0)
    s_and_b32 s13, s13, 0xffff
    s_mov_b32 s14, 1204224
    s_mov_b32 s15, 0x20000
    s_and_b32 s17, s17, 0xffff
    s_mov_b32 s18, 1605632
    s_mov_b32 s19, 0x20000
    s_and_b32 s21, s21, 0xffff
    s_mov_b32 s22, 1605632
    s_mov_b32 s23, 0x20000
    s_and_b32 s25, s25, 0xffff
    s_mov_b32 s26, 67108864
    s_mov_b32 s27, 0x20000
    s_lshl_b32 s7, s4, 8
    s_lshl_b32 s30, s6, 5
    s_add_u32 s7, s7, s30
    v_and_b32 v3, 31, v1
    v_lshrrev_b32 v4, 5, v1
    v_lshlrev_b32 v5, 4, v1
    v_lshrrev_b32 v6, 5, v1
    v_lshlrev_b32 v6, 9, v6
    v_bfe_u32 v7, v1, 2, 2
    v_lshl_add_u32 v6, v7, 6, v6
    v_bfe_u32 v7, v1, 4, 1
    v_lshl_add_u32 v6, v7, 5, v6
    v_and_b32 v7, 3, v1
    v_lshl_add_u32 v6, v7, 3, v6
    v_lshrrev_b32 v7, 4, v1
    v_lshlrev_b32 v7, 2, v7
    v_bfe_u32 v8, v1, 2, 2
    v_add_u32 v7, v7, v8
    s_movk_i32 s30, 3584
    v_mul_lo_u32 v7, v7, s30
    v_and_b32 v8, 3, v1
    v_lshl_add_u32 v7, v8, 4, v7
    v_add_u32 v8, s7, v3
    s_lshr_b32 s30, s7, 5
    s_lshl_b32 s31, s30, 15
    s_lshl_b32 s33, s5, 11
    s_add_u32 s31, s31, s33
    v_add_u32 v9, s31, v5
    s_mul_i32 s31, s30, 114688
    s_mul_i32 s33, s5, 7168
    s_add_u32 s31, s31, s33
    s_add_u32 s31, s31, 2097152
    v_add_u32 v15, s31, v5
    s_mul_i32 s35, s5, 224
    s_cmp_ge_u32 s2, 128
    s_cbranch_scc1 K1_typeB
    s_mul_i32 s39, s5, 86016
    s_add_u32 s39, s39, 20971520
    s_add_u32 s38, s6, 0
    s_lshl_b32 s38, s38, 10
    s_add_u32 s30, s38, 0
    s_mov_b32 m0, s30
    s_add_u32 s30, s38, s39
    buffer_load_dwordx4 v5, s[24:27], s30 offen lds
    s_add_u32 s38, s6, 8
    s_lshl_b32 s38, s38, 10
    s_add_u32 s30, s38, 0
    s_mov_b32 m0, s30
    s_add_u32 s30, s38, s39
    buffer_load_dwordx4 v5, s[24:27], s30 offen lds
    s_add_u32 s38, s6, 16
    s_lshl_b32 s38, s38, 10
    s_add_u32 s30, s38, 0
    s_mov_b32 m0, s30
    s_add_u32 s30, s38, s39
    buffer_load_dwordx4 v5, s[24:27], s30 offen lds
    s_and_b32 s38, s6, 3
    s_add_u32 s38, s38, 24
    s_lshl_b32 s38, s38, 10
    s_add_u32 s30, s38, 0
    s_mov_b32 m0, s30
    s_add_u32 s30, s38, s39
    buffer_load_dwordx4 v5, s[24:27], s30 offen lds
    s_lshr_b32 s30, s7, 5
    s_mul_i32 s30, s30, 28672
    s_add_u32 s30, s30, 14680064
    buffer_load_dwordx4 v[16:19], v5, s[24:27], s30 offen offset:0
    buffer_load_dwordx4 v[20:23], v5, s[24:27], s30 offen offset:1024
    buffer_load_dwordx4 v[24:27], v5, s[24:27], s30 offen offset:2048
    buffer_load_dwordx4 v[28:31], v5, s[24:27], s30 offen offset:3072
    s_add_u32 s30, s30, 4096
    buffer_load_dwordx4 v[32:35], v5, s[24:27], s30 offen offset:0
    buffer_load_dwordx4 v[36:39], v5, s[24:27], s30 offen offset:1024
    buffer_load_dwordx4 v[40:43], v5, s[24:27], s30 offen offset:2048
    buffer_load_dwordx4 v[44:47], v5, s[24:27], s30 offen offset:3072
    s_add_u32 s30, s30, 4096
    buffer_load_dwordx4 v[48:51], v5, s[24:27], s30 offen offset:0
    buffer_load_dwordx4 v[52:55], v5, s[24:27], s30 offen offset:1024
    buffer_load_dwordx4 v[56:59], v5, s[24:27], s30 offen offset:2048
    buffer_load_dwordx4 v[60:63], v5, s[24:27], s30 offen offset:3072
    s_add_u32 s30, s30, 4096
    buffer_load_dwordx4 v[64:67], v5, s[24:27], s30 offen offset:0
    buffer_load_dwordx4 v[68:71], v5, s[24:27], s30 offen offset:1024
    buffer_load_dwordx4 v[72:75], v5, s[24:27], s30 offen offset:2048
    buffer_load_dwordx4 v[76:79], v5, s[24:27], s30 offen offset:3072
    s_add_u32 s30, s30, 4096
    buffer_load_dwordx4 v[80:83], v5, s[24:27], s30 offen offset:0
    buffer_load_dwordx4 v[84:87], v5, s[24:27], s30 offen offset:1024
    buffer_load_dwordx4 v[88:91], v5, s[24:27], s30 offen offset:2048
    buffer_load_dwordx4 v[92:95], v5, s[24:27], s30 offen offset:3072
    s_add_u32 s30, s30, 4096
    buffer_load_dwordx4 v[96:99], v5, s[24:27], s30 offen offset:0
    buffer_load_dwordx4 v[100:103], v5, s[24:27], s30 offen offset:1024
    buffer_load_dwordx4 v[104:107], v5, s[24:27], s30 offen offset:2048
    buffer_load_dwordx4 v[108:111], v5, s[24:27], s30 offen offset:3072
    s_add_u32 s30, s30, 4096
    buffer_load_dwordx4 v[112:115], v5, s[24:27], s30 offen offset:0
    buffer_load_dwordx4 v[116:119], v5, s[24:27], s30 offen offset:1024
    buffer_load_dwordx4 v[120:123], v5, s[24:27], s30 offen offset:2048
    buffer_load_dwordx4 v[124:127], v5, s[24:27], s30 offen offset:3072
    s_add_u32 s30, s30, 4096
    s_waitcnt vmcnt(28)
    s_waitcnt lgkmcnt(0)
    s_barrier
    s_mul_i32 s39, s5, 86016
    s_add_u32 s39, s39, 21000192
    s_add_u32 s38, s6, 0
    s_lshl_b32 s38, s38, 10
    s_add_u32 s30, s38, 28672
    s_mov_b32 m0, s30
    s_add_u32 s30, s38, s39
    buffer_load_dwordx4 v5, s[24:27], s30 offen lds
    s_add_u32 s38, s6, 8
    s_lshl_b32 s38, s38, 10
    s_add_u32 s30, s38, 28672
    s_mov_b32 m0, s30
    s_add_u32 s30, s38, s39
    buffer_load_dwordx4 v5, s[24:27], s30 offen lds
    s_add_u32 s38, s6, 16
    s_lshl_b32 s38, s38, 10
    s_add_u32 s30, s38, 28672
    s_mov_b32 m0, s30
    s_add_u32 s30, s38, s39
    buffer_load_dwordx4 v5, s[24:27], s30 offen lds
    s_and_b32 s38, s6, 3
    s_add_u32 s38, s38, 24
    s_lshl_b32 s38, s38, 10
    s_add_u32 s30, s38, 28672
    s_mov_b32 m0, s30
    s_add_u32 s30, s38, s39
    buffer_load_dwordx4 v5, s[24:27], s30 offen lds
    v_mov_b32 v128, 0
    v_mov_b32 v129, 0
    v_mov_b32 v130, 0
    v_mov_b32 v131, 0
    v_mov_b32 v132, 0
    v_mov_b32 v133, 0
    v_mov_b32 v134, 0
    v_mov_b32 v135, 0
    v_mov_b32 v136, 0
    v_mov_b32 v137, 0
    v_mov_b32 v138, 0
    v_mov_b32 v139, 0
    v_mov_b32 v140, 0
    v_mov_b32 v141, 0
    v_mov_b32 v142, 0
    v_mov_b32 v143, 0
    v_add_u32 v2, 0, v6
    ds_read_b64_tr_b16 v[192:193], v2 offset:0
    ds_read_b64_tr_b16 v[194:195], v2 offset:256
    ds_read_b64_tr_b16 v[196:197], v2 offset:1024
    ds_read_b64_tr_b16 v[198:199], v2 offset:1280
    ds_read_b64_tr_b16 v[200:201], v2 offset:2048
    ds_read_b64_tr_b16 v[202:203], v2 offset:2304
    ds_read_b64_tr_b16 v[204:205], v2 offset:3072
    ds_read_b64_tr_b16 v[206:207], v2 offset:3328
    ds_read_b64_tr_b16 v[208:209], v2 offset:4096
    ds_read_b64_tr_b16 v[210:211], v2 offset:4352
    s_waitcnt vmcnt(31)
    s_waitcnt lgkmcnt(8)
    v_mfma_f32_32x32x16_bf16 v[128:143], v[192:195], v[16:19], v[128:143]
    ds_read_b64_tr_b16 v[212:213], v2 offset:5120
    ds_read_b64_tr_b16 v[214:215], v2 offset:5376
    s_waitcnt vmcnt(30)
    s_waitcnt lgkmcnt(8)
    v_mfma_f32_32x32x16_bf16 v[128:143], v[196:199], v[20:23], v[128:143]
    ds_read_b64_tr_b16 v[192:193], v2 offset:6144
    ds_read_b64_tr_b16 v[194:195], v2 offset:6400
    s_waitcnt vmcnt(29)
    s_waitcnt lgkmcnt(8)
    v_mfma_f32_32x32x16_bf16 v[128:143], v[200:203], v[24:27], v[128:143]
    ds_read_b64_tr_b16 v[196:197], v2 offset:7168
    ds_read_b64_tr_b16 v[198:199], v2 offset:7424
    s_waitcnt vmcnt(28)
    s_waitcnt lgkmcnt(8)
    v_mfma_f32_32x32x16_bf16 v[128:143], v[204:207], v[28:31], v[128:143]
    ds_read_b64_tr_b16 v[200:201], v2 offset:8192
    ds_read_b64_tr_b16 v[202:203], v2 offset:8448
    s_waitcnt vmcnt(27)
    s_waitcnt lgkmcnt(8)
    v_mfma_f32_32x32x16_bf16 v[128:143], v[208:211], v[32:35], v[128:143]
    ds_read_b64_tr_b16 v[204:205], v2 offset:9216
    ds_read_b64_tr_b16 v[206:207], v2 offset:9472
    s_waitcnt vmcnt(26)
    s_waitcnt lgkmcnt(8)
    v_mfma_f32_32x32x16_bf16 v[128:143], v[212:215], v[36:39], v[128:143]
    ds_read_b64_tr_b16 v[208:209], v2 offset:10240
    ds_read_b64_tr_b16 v[210:211], v2 offset:10496
    s_waitcnt vmcnt(25)
    s_waitcnt lgkmcnt(8)
    v_mfma_f32_32x32x16_bf16 v[128:143], v[192:195], v[40:43], v[128:143]
    ds_read_b64_tr_b16 v[212:213], v2 offset:11264
    ds_read_b64_tr_b16 v[214:215], v2 offset:11520
    s_waitcnt vmcnt(24)
    s_waitcnt lgkmcnt(8)
    v_mfma_f32_32x32x16_bf16 v[128:143], v[196:199], v[44:47], v[128:143]
    ds_read_b64_tr_b16 v[192:193], v2 offset:12288
    ds_read_b64_tr_b16 v[194:195], v2 offset:12544
    s_waitcnt vmcnt(23)
    s_waitcnt lgkmcnt(8)
    v_mfma_f32_32x32x16_bf16 v[128:143], v[200:203], v[48:51], v[128:143]
    ds_read_b64_tr_b16 v[196:197], v2 offset:13312
    ds_read_b64_tr_b16 v[198:199], v2 offset:13568
    s_waitcnt vmcnt(22)
    s_waitcnt lgkmcnt(8)
    v_mfma_f32_32x32x16_bf16 v[128:143], v[204:207], v[52:55], v[128:143]
    ds_read_b64_tr_b16 v[200:201], v2 offset:14336
    ds_read_b64_tr_b16 v[202:203], v2 offset:14592
    s_waitcnt vmcnt(21)
    s_waitcnt lgkmcnt(8)
    v_mfma_f32_32x32x16_bf16 v[128:143], v[208:211], v[56:59], v[128:143]
    ds_read_b64_tr_b16 v[204:205], v2 offset:15360
    ds_read_b64_tr_b16 v[206:207], v2 offset:15616
    s_waitcnt vmcnt(20)
    s_waitcnt lgkmcnt(8)
    v_mfma_f32_32x32x16_bf16 v[128:143], v[212:215], v[60:63], v[128:143]
    ds_read_b64_tr_b16 v[208:209], v2 offset:16384
    ds_read_b64_tr_b16 v[210:211], v2 offset:16640
    s_waitcnt vmcnt(19)
    s_waitcnt lgkmcnt(8)
    v_mfma_f32_32x32x16_bf16 v[128:143], v[192:195], v[64:67], v[128:143]
    ds_read_b64_tr_b16 v[212:213], v2 offset:17408
    ds_read_b64_tr_b16 v[214:215], v2 offset:17664
    s_waitcnt vmcnt(18)
    s_waitcnt lgkmcnt(8)
    v_mfma_f32_32x32x16_bf16 v[128:143], v[196:199], v[68:71], v[128:143]
    ds_read_b64_tr_b16 v[192:193], v2 offset:18432
    ds_read_b64_tr_b16 v[194:195], v2 offset:18688
    s_waitcnt vmcnt(17)
    s_waitcnt lgkmcnt(8)
    v_mfma_f32_32x32x16_bf16 v[128:143], v[200:203], v[72:75], v[128:143]
    ds_read_b64_tr_b16 v[196:197], v2 offset:19456
    ds_read_b64_tr_b16 v[198:199], v2 offset:19712
    s_waitcnt vmcnt(16)
    s_waitcnt lgkmcnt(8)
    v_mfma_f32_32x32x16_bf16 v[128:143], v[204:207], v[76:79], v[128:143]
    ds_read_b64_tr_b16 v[200:201], v2 offset:20480
    ds_read_b64_tr_b16 v[202:203], v2 offset:20736
    s_waitcnt vmcnt(15)
    s_waitcnt lgkmcnt(8)
    v_mfma_f32_32x32x16_bf16 v[128:143], v[208:211], v[80:83], v[128:143]
    ds_read_b64_tr_b16 v[204:205], v2 offset:21504
    ds_read_b64_tr_b16 v[206:207], v2 offset:21760
    s_waitcnt vmcnt(14)
    s_waitcnt lgkmcnt(8)
    v_mfma_f32_32x32x16_bf16 v[128:143], v[212:215], v[84:87], v[128:143]
    ds_read_b64_tr_b16 v[208:209], v2 offset:22528
    ds_read_b64_tr_b16 v[210:211], v2 offset:22784
    s_waitcnt vmcnt(13)
    s_waitcnt lgkmcnt(8)
    v_mfma_f32_32x32x16_bf16 v[128:143], v[192:195], v[88:91], v[128:143]
    ds_read_b64_tr_b16 v[212:213], v2 offset:23552
    ds_read_b64_tr_b16 v[214:215], v2 offset:23808
    s_waitcnt vmcnt(12)
    s_waitcnt lgkmcnt(8)
    v_mfma_f32_32x32x16_bf16 v[128:143], v[196:199], v[92:95], v[128:143]
    ds_read_b64_tr_b16 v[192:193], v2 offset:24576
    ds_read_b64_tr_b16 v[194:195], v2 offset:24832
    s_waitcnt vmcnt(11)
    s_waitcnt lgkmcnt(8)
    v_mfma_f32_32x32x16_bf16 v[128:143], v[200:203], v[96:99], v[128:143]
    ds_read_b64_tr_b16 v[196:197], v2 offset:25600
    ds_read_b64_tr_b16 v[198:199], v2 offset:25856
    s_waitcnt vmcnt(10)
    s_waitcnt lgkmcnt(8)
    v_mfma_f32_32x32x16_bf16 v[128:143], v[204:207], v[100:103], v[128:143]
    ds_read_b64_tr_b16 v[200:201], v2 offset:26624
    ds_read_b64_tr_b16 v[202:203], v2 offset:26880
    s_waitcnt vmcnt(9)
    s_waitcnt lgkmcnt(8)
    v_mfma_f32_32x32x16_bf16 v[128:143], v[208:211], v[104:107], v[128:143]
    ds_read_b64_tr_b16 v[204:205], v2 offset:27648
    ds_read_b64_tr_b16 v[206:207], v2 offset:27904
    s_waitcnt vmcnt(8)
    s_waitcnt lgkmcnt(8)
    v_mfma_f32_32x32x16_bf16 v[128:143], v[212:215], v[108:111], v[128:143]
    s_waitcnt vmcnt(7)
    s_waitcnt lgkmcnt(6)
    v_mfma_f32_32x32x16_bf16 v[128:143], v[192:195], v[112:115], v[128:143]
    s_waitcnt vmcnt(6)
    s_waitcnt lgkmcnt(4)
    v_mfma_f32_32x32x16_bf16 v[128:143], v[196:199], v[116:119], v[128:143]
    s_waitcnt vmcnt(5)
    s_waitcnt lgkmcnt(2)
    v_mfma_f32_32x32x16_bf16 v[128:143], v[200:203], v[120:123], v[128:143]
    s_waitcnt vmcnt(4)
    s_waitcnt lgkmcnt(0)
    v_mfma_f32_32x32x16_bf16 v[128:143], v[204:207], v[124:127], v[128:143]
    s_waitcnt vmcnt(0)
    s_waitcnt lgkmcnt(0)
    s_barrier
    s_mul_i32 s39, s5, 86016
    s_add_u32 s39, s39, 21028864
    s_add_u32 s38, s6, 0
    s_lshl_b32 s38, s38, 10
    s_add_u32 s30, s38, 0
    s_mov_b32 m0, s30
    s_add_u32 s30, s38, s39
    buffer_load_dwordx4 v5, s[24:27], s30 offen lds
    s_add_u32 s38, s6, 8
    s_lshl_b32 s38, s38, 10
    s_add_u32 s30, s38, 0
    s_mov_b32 m0, s30
    s_add_u32 s30, s38, s39
    buffer_load_dwordx4 v5, s[24:27], s30 offen lds
    s_add_u32 s38, s6, 16
    s_lshl_b32 s38, s38, 10
    s_add_u32 s30, s38, 0
    s_mov_b32 m0, s30
    s_add_u32 s30, s38, s39
    buffer_load_dwordx4 v5, s[24:27], s30 offen lds
    s_and_b32 s38, s6, 3
    s_add_u32 s38, s38, 24
    s_lshl_b32 s38, s38, 10
    s_add_u32 s30, s38, 0
    s_mov_b32 m0, s30
    s_add_u32 s30, s38, s39
    buffer_load_dwordx4 v5, s[24:27], s30 offen lds
    v_mov_b32 v160, 0
    v_mov_b32 v161, 0
    v_mov_b32 v162, 0
    v_mov_b32 v163, 0
    v_mov_b32 v164, 0
    v_mov_b32 v165, 0
    v_mov_b32 v166, 0
    v_mov_b32 v167, 0
    v_mov_b32 v168, 0
    v_mov_b32 v169, 0
    v_mov_b32 v170, 0
    v_mov_b32 v171, 0
    v_mov_b32 v172, 0
    v_mov_b32 v173, 0
    v_mov_b32 v174, 0
    v_mov_b32 v175, 0
    v_add_u32 v2, 28672, v6
    ds_read_b64_tr_b16 v[192:193], v2 offset:0
    ds_read_b64_tr_b16 v[194:195], v2 offset:256
    ds_read_b64_tr_b16 v[196:197], v2 offset:1024
    ds_read_b64_tr_b16 v[198:199], v2 offset:1280
    ds_read_b64_tr_b16 v[200:201], v2 offset:2048
    ds_read_b64_tr_b16 v[202:203], v2 offset:2304
    ds_read_b64_tr_b16 v[204:205], v2 offset:3072
    ds_read_b64_tr_b16 v[206:207], v2 offset:3328
    ds_read_b64_tr_b16 v[208:209], v2 offset:4096
    ds_read_b64_tr_b16 v[210:211], v2 offset:4352
    s_waitcnt lgkmcnt(8)
    v_mfma_f32_32x32x16_bf16 v[160:175], v[16:19], v[192:195], v[160:175]
    ds_read_b64_tr_b16 v[212:213], v2 offset:5120
    ds_read_b64_tr_b16 v[214:215], v2 offset:5376
    s_waitcnt lgkmcnt(8)
    v_mfma_f32_32x32x16_bf16 v[160:175], v[20:23], v[196:199], v[160:175]
    v_cvt_pk_bf16_f32 v216, v128, v129
    v_lshlrev_b32 v128, 16, v216
    v_and_b32 v129, 0xffff0000, v216
    v_mul_f32 v216, s90, v128
    v_mul_f32 v217, s90, v129
    v_exp_f32 v216, v216
    v_exp_f32 v217, v217
    ds_read_b64_tr_b16 v[192:193], v2 offset:6144
    ds_read_b64_tr_b16 v[194:195], v2 offset:6400
    s_waitcnt lgkmcnt(8)
    v_mfma_f32_32x32x16_bf16 v[160:175], v[24:27], v[200:203], v[160:175]
    v_add_f32 v218, 1.0, v128
    v_add_f32 v219, 1.0, v129
    v_cmp_lt_f32 vcc, 0, v128
    s_nop 1
    v_cndmask_b32 v128, v216, v218, vcc
    v_cmp_lt_f32 vcc, 0, v129
    s_nop 1
    ds_read_b64_tr_b16 v[196:197], v2 offset:7168
    ds_read_b64_tr_b16 v[198:199], v2 offset:7424
    s_waitcnt lgkmcnt(8)
    v_mfma_f32_32x32x16_bf16 v[160:175], v[28:31], v[204:207], v[160:175]
    v_cndmask_b32 v129, v217, v219, vcc
    v_cvt_pk_bf16_f32 v216, v128, v129
    v_lshlrev_b32 v128, 16, v216
    v_and_b32 v129, 0xffff0000, v216
    v_add_f32 v128, s91, v128
    v_add_f32 v129, s91, v129
    v_cvt_pk_bf16_f32 v224, v128, v129
    ds_read_b64_tr_b16 v[200:201], v2 offset:8192
    ds_read_b64_tr_b16 v[202:203], v2 offset:8448
    s_waitcnt lgkmcnt(8)
    v_mfma_f32_32x32x16_bf16 v[160:175], v[32:35], v[208:211], v[160:175]
    v_cvt_pk_bf16_f32 v216, v130, v131
    v_lshlrev_b32 v130, 16, v216
    v_and_b32 v131, 0xffff0000, v216
    v_mul_f32 v216, s90, v130
    v_mul_f32 v217, s90, v131
    v_exp_f32 v216, v216
    v_exp_f32 v217, v217
    ds_read_b64_tr_b16 v[204:205], v2 offset:9216
    ds_read_b64_tr_b16 v[206:207], v2 offset:9472
    s_waitcnt lgkmcnt(8)
    v_mfma_f32_32x32x16_bf16 v[160:175], v[36:39], v[212:215], v[160:175]
    v_add_f32 v218, 1.0, v130
    v_add_f32 v219, 1.0, v131
    v_cmp_lt_f32 vcc, 0, v130
    s_nop 1
    v_cndmask_b32 v130, v216, v218, vcc
    v_cmp_lt_f32 vcc, 0, v131
    s_nop 1
    ds_read_b64_tr_b16 v[208:209], v2 offset:10240
    ds_read_b64_tr_b16 v[210:211], v2 offset:10496
    s_waitcnt lgkmcnt(8)
    v_mfma_f32_32x32x16_bf16 v[160:175], v[40:43], v[192:195], v[160:175]
    v_cndmask_b32 v131, v217, v219, vcc
    v_cvt_pk_bf16_f32 v216, v130, v131
    v_lshlrev_b32 v130, 16, v216
    v_and_b32 v131, 0xffff0000, v216
    v_add_f32 v130, s91, v130
    v_add_f32 v131, s91, v131
    v_cvt_pk_bf16_f32 v225, v130, v131
    ds_read_b64_tr_b16 v[212:213], v2 offset:11264
    ds_read_b64_tr_b16 v[214:215], v2 offset:11520
    s_waitcnt lgkmcnt(8)
    v_mfma_f32_32x32x16_bf16 v[160:175], v[44:47], v[196:199], v[160:175]
    v_cvt_pk_bf16_f32 v216, v132, v133
    v_lshlrev_b32 v132, 16, v216
    v_and_b32 v133, 0xffff0000, v216
    v_mul_f32 v216, s90, v132
    v_mul_f32 v217, s90, v133
    v_exp_f32 v216, v216
    v_exp_f32 v217, v217
    ds_read_b64_tr_b16 v[192:193], v2 offset:12288
    ds_read_b64_tr_b16 v[194:195], v2 offset:12544
    s_waitcnt lgkmcnt(8)
    v_mfma_f32_32x32x16_bf16 v[160:175], v[48:51], v[200:203], v[160:175]
    v_add_f32 v218, 1.0, v132
    v_add_f32 v219, 1.0, v133
    v_cmp_lt_f32 vcc, 0, v132
    s_nop 1
    v_cndmask_b32 v132, v216, v218, vcc
    v_cmp_lt_f32 vcc, 0, v133
    s_nop 1
    ds_read_b64_tr_b16 v[196:197], v2 offset:13312
    ds_read_b64_tr_b16 v[198:199], v2 offset:13568
    s_waitcnt lgkmcnt(8)
    v_mfma_f32_32x32x16_bf16 v[160:175], v[52:55], v[204:207], v[160:175]
    v_cndmask_b32 v133, v217, v219, vcc
    v_cvt_pk_bf16_f32 v216, v132, v133
    v_lshlrev_b32 v132, 16, v216
    v_and_b32 v133, 0xffff0000, v216
    v_add_f32 v132, s91, v132
    v_add_f32 v133, s91, v133
    v_cvt_pk_bf16_f32 v226, v132, v133
    ds_read_b64_tr_b16 v[200:201], v2 offset:14336
    ds_read_b64_tr_b16 v[202:203], v2 offset:14592
    s_waitcnt lgkmcnt(8)
    v_mfma_f32_32x32x16_bf16 v[160:175], v[56:59], v[208:211], v[160:175]
    v_cvt_pk_bf16_f32 v216, v134, v135
    v_lshlrev_b32 v134, 16, v216
    v_and_b32 v135, 0xffff0000, v216
    v_mul_f32 v216, s90, v134
    v_mul_f32 v217, s90, v135
    v_exp_f32 v216, v216
    v_exp_f32 v217, v217
    ds_read_b64_tr_b16 v[204:205], v2 offset:15360
    ds_read_b64_tr_b16 v[206:207], v2 offset:15616
    s_waitcnt lgkmcnt(8)
    v_mfma_f32_32x32x16_bf16 v[160:175], v[60:63], v[212:215], v[160:175]
    v_add_f32 v218, 1.0, v134
    v_add_f32 v219, 1.0, v135
    v_cmp_lt_f32 vcc, 0, v134
    s_nop 1
    v_cndmask_b32 v134, v216, v218, vcc
    v_cmp_lt_f32 vcc, 0, v135
    s_nop 1
    ds_read_b64_tr_b16 v[208:209], v2 offset:16384
    ds_read_b64_tr_b16 v[210:211], v2 offset:16640
    s_waitcnt lgkmcnt(8)
    v_mfma_f32_32x32x16_bf16 v[160:175], v[64:67], v[192:195], v[160:175]
    v_cndmask_b32 v135, v217, v219, vcc
    v_cvt_pk_bf16_f32 v216, v134, v135
    v_lshlrev_b32 v134, 16, v216
    v_and_b32 v135, 0xffff0000, v216
    v_add_f32 v134, s91, v134
    v_add_f32 v135, s91, v135
    v_cvt_pk_bf16_f32 v227, v134, v135
    ds_read_b64_tr_b16 v[212:213], v2 offset:17408
    ds_read_b64_tr_b16 v[214:215], v2 offset:17664
    s_waitcnt lgkmcnt(8)
    v_mfma_f32_32x32x16_bf16 v[160:175], v[68:71], v[196:199], v[160:175]
    v_cvt_pk_bf16_f32 v216, v136, v137
    v_lshlrev_b32 v136, 16, v216
    v_and_b32 v137, 0xffff0000, v216
    v_mul_f32 v216, s90, v136
    v_mul_f32 v217, s90, v137
    v_exp_f32 v216, v216
    v_exp_f32 v217, v217
    ds_read_b64_tr_b16 v[192:193], v2 offset:18432
    ds_read_b64_tr_b16 v[194:195], v2 offset:18688
    s_waitcnt lgkmcnt(8)
    v_mfma_f32_32x32x16_bf16 v[160:175], v[72:75], v[200:203], v[160:175]
    v_add_f32 v218, 1.0, v136
    v_add_f32 v219, 1.0, v137
    v_cmp_lt_f32 vcc, 0, v136
    s_nop 1
    v_cndmask_b32 v136, v216, v218, vcc
    v_cmp_lt_f32 vcc, 0, v137
    s_nop 1
    ds_read_b64_tr_b16 v[196:197], v2 offset:19456
    ds_read_b64_tr_b16 v[198:199], v2 offset:19712
    s_waitcnt lgkmcnt(8)
    v_mfma_f32_32x32x16_bf16 v[160:175], v[76:79], v[204:207], v[160:175]
    v_cndmask_b32 v137, v217, v219, vcc
    v_cvt_pk_bf16_f32 v216, v136, v137
    v_lshlrev_b32 v136, 16, v216
    v_and_b32 v137, 0xffff0000, v216
    v_add_f32 v136, s91, v136
    v_add_f32 v137, s91, v137
    v_cvt_pk_bf16_f32 v228, v136, v137
    ds_read_b64_tr_b16 v[200:201], v2 offset:20480
    ds_read_b64_tr_b16 v[202:203], v2 offset:20736
    s_waitcnt lgkmcnt(8)
    v_mfma_f32_32x32x16_bf16 v[160:175], v[80:83], v[208:211], v[160:175]
    v_cvt_pk_bf16_f32 v216, v138, v139
    v_lshlrev_b32 v138, 16, v216
    v_and_b32 v139, 0xffff0000, v216
    v_mul_f32 v216, s90, v138
    v_mul_f32 v217, s90, v139
    v_exp_f32 v216, v216
    v_exp_f32 v217, v217
    ds_read_b64_tr_b16 v[204:205], v2 offset:21504
    ds_read_b64_tr_b16 v[206:207], v2 offset:21760
    s_waitcnt lgkmcnt(8)
    v_mfma_f32_32x32x16_bf16 v[160:175], v[84:87], v[212:215], v[160:175]
    v_add_f32 v218, 1.0, v138
    v_add_f32 v219, 1.0, v139
    v_cmp_lt_f32 vcc, 0, v138
    s_nop 1
    v_cndmask_b32 v138, v216, v218, vcc
    v_cmp_lt_f32 vcc, 0, v139
    s_nop 1
    ds_read_b64_tr_b16 v[208:209], v2 offset:22528
    ds_read_b64_tr_b16 v[210:211], v2 offset:22784
    s_waitcnt lgkmcnt(8)
    v_mfma_f32_32x32x16_bf16 v[160:175], v[88:91], v[192:195], v[160:175]
    v_cndmask_b32 v139, v217, v219, vcc
    v_cvt_pk_bf16_f32 v216, v138, v139
    v_lshlrev_b32 v138, 16, v216
    v_and_b32 v139, 0xffff0000, v216
    v_add_f32 v138, s91, v138
    v_add_f32 v139, s91, v139
    v_cvt_pk_bf16_f32 v229, v138, v139
    ds_read_b64_tr_b16 v[212:213], v2 offset:23552
    ds_read_b64_tr_b16 v[214:215], v2 offset:23808
    s_waitcnt lgkmcnt(8)
    v_mfma_f32_32x32x16_bf16 v[160:175], v[92:95], v[196:199], v[160:175]
    v_cvt_pk_bf16_f32 v216, v140, v141
    v_lshlrev_b32 v140, 16, v216
    v_and_b32 v141, 0xffff0000, v216
    v_mul_f32 v216, s90, v140
    v_mul_f32 v217, s90, v141
    v_exp_f32 v216, v216
    v_exp_f32 v217, v217
    ds_read_b64_tr_b16 v[192:193], v2 offset:24576
    ds_read_b64_tr_b16 v[194:195], v2 offset:24832
    s_waitcnt lgkmcnt(8)
    v_mfma_f32_32x32x16_bf16 v[160:175], v[96:99], v[200:203], v[160:175]
    v_add_f32 v218, 1.0, v140
    v_add_f32 v219, 1.0, v141
    v_cmp_lt_f32 vcc, 0, v140
    s_nop 1
    v_cndmask_b32 v140, v216, v218, vcc
    v_cmp_lt_f32 vcc, 0, v141
    s_nop 1
    ds_read_b64_tr_b16 v[196:197], v2 offset:25600
    ds_read_b64_tr_b16 v[198:199], v2 offset:25856
    s_waitcnt lgkmcnt(8)
    v_mfma_f32_32x32x16_bf16 v[160:175], v[100:103], v[204:207], v[160:175]
    v_cndmask_b32 v141, v217, v219, vcc
    v_cvt_pk_bf16_f32 v216, v140, v141
    v_lshlrev_b32 v140, 16, v216
    v_and_b32 v141, 0xffff0000, v216
    v_add_f32 v140, s91, v140
    v_add_f32 v141, s91, v141
    v_cvt_pk_bf16_f32 v230, v140, v141
    ds_read_b64_tr_b16 v[200:201], v2 offset:26624
    ds_read_b64_tr_b16 v[202:203], v2 offset:26880
    s_waitcnt lgkmcnt(8)
    v_mfma_f32_32x32x16_bf16 v[160:175], v[104:107], v[208:211], v[160:175]
    v_cvt_pk_bf16_f32 v216, v142, v143
    v_lshlrev_b32 v142, 16, v216
    v_and_b32 v143, 0xffff0000, v216
    v_mul_f32 v216, s90, v142
    v_mul_f32 v217, s90, v143
    v_exp_f32 v216, v216
    v_exp_f32 v217, v217
    ds_read_b64_tr_b16 v[204:205], v2 offset:27648
    ds_read_b64_tr_b16 v[206:207], v2 offset:27904
    s_waitcnt lgkmcnt(8)
    v_mfma_f32_32x32x16_bf16 v[160:175], v[108:111], v[212:215], v[160:175]
    v_add_f32 v218, 1.0, v142
    v_add_f32 v219, 1.0, v143
    v_cmp_lt_f32 vcc, 0, v142
    s_nop 1
    v_cndmask_b32 v142, v216, v218, vcc
    v_cmp_lt_f32 vcc, 0, v143
    s_nop 1
    s_waitcnt lgkmcnt(6)
    v_mfma_f32_32x32x16_bf16 v[160:175], v[112:115], v[192:195], v[160:175]
    v_cndmask_b32 v143, v217, v219, vcc
    v_cvt_pk_bf16_f32 v216, v142, v143
    v_lshlrev_b32 v142, 16, v216
    v_and_b32 v143, 0xffff0000, v216
    v_add_f32 v142, s91, v142
    v_add_f32 v143, s91, v143
    v_cvt_pk_bf16_f32 v231, v142, v143
    s_waitcnt lgkmcnt(4)
    v_mfma_f32_32x32x16_bf16 v[160:175], v[116:119], v[196:199], v[160:175]
    buffer_store_dwordx4 v[224:227], v9, s[24:27], 0 offen
    buffer_store_dwordx4 v[228:231], v9, s[24:27], 0 offen offset:1024
    s_nop 1
    s_waitcnt lgkmcnt(2)
    v_mfma_f32_32x32x16_bf16 v[160:175], v[120:123], v[200:203], v[160:175]
    s_waitcnt lgkmcnt(0)
    v_mfma_f32_32x32x16_bf16 v[160:175], v[124:127], v[204:207], v[160:175]
    s_waitcnt vmcnt(2)
    s_waitcnt lgkmcnt(0)
    s_barrier
    s_mul_i32 s39, s5, 229376
    s_add_u32 s39, s39, 16777216
    s_add_u32 s38, s6, 0
    s_lshl_b32 s38, s38, 10
    s_add_u32 s30, s38, 28672
    s_mov_b32 m0, s30
    s_add_u32 s30, s38, s39
    buffer_load_dwordx4 v5, s[24:27], s30 offen lds
    s_add_u32 s38, s6, 8
    s_lshl_b32 s38, s38, 10
    s_add_u32 s30, s38, 28672
    s_mov_b32 m0, s30
    s_add_u32 s30, s38, s39
    buffer_load_dwordx4 v5, s[24:27], s30 offen lds
    s_add_u32 s38, s6, 16
    s_lshl_b32 s38, s38, 10
    s_add_u32 s30, s38, 28672
    s_mov_b32 m0, s30
    s_add_u32 s30, s38, s39
    buffer_load_dwordx4 v5, s[24:27], s30 offen lds
    s_and_b32 s38, s6, 3
    s_add_u32 s38, s38, 24
    s_lshl_b32 s38, s38, 10
    s_add_u32 s30, s38, 28672
    s_mov_b32 m0, s30
    s_add_u32 s30, s38, s39
    buffer_load_dwordx4 v5, s[24:27], s30 offen lds
    v_mov_b32 v128, 0
    v_mov_b32 v129, 0
    v_mov_b32 v130, 0
    v_mov_b32 v131, 0
    v_mov_b32 v132, 0
    v_mov_b32 v133, 0
    v_mov_b32 v134, 0
    v_mov_b32 v135, 0
    v_mov_b32 v136, 0
    v_mov_b32 v137, 0
    v_mov_b32 v138, 0
    v_mov_b32 v139, 0
    v_mov_b32 v140, 0
    v_mov_b32 v141, 0
    v_mov_b32 v142, 0
    v_mov_b32 v143, 0
    v_add_u32 v2, 0, v6
    ds_read_b64_tr_b16 v[192:193], v2 offset:0
    ds_read_b64_tr_b16 v[194:195], v2 offset:256
    ds_read_b64_tr_b16 v[196:197], v2 offset:1024
    ds_read_b64_tr_b16 v[198:199], v2 offset:1280
    ds_read_b64_tr_b16 v[200:201], v2 offset:2048
    ds_read_b64_tr_b16 v[202:203], v2 offset:2304
    ds_read_b64_tr_b16 v[204:205], v2 offset:3072
    ds_read_b64_tr_b16 v[206:207], v2 offset:3328
    ds_read_b64_tr_b16 v[208:209], v2 offset:4096
    ds_read_b64_tr_b16 v[210:211], v2 offset:4352
    s_waitcnt lgkmcnt(8)
    v_mfma_f32_32x32x16_bf16 v[128:143], v[16:19], v[192:195], v[128:143]
    ds_read_b64_tr_b16 v[212:213], v2 offset:5120
    ds_read_b64_tr_b16 v[214:215], v2 offset:5376
    s_waitcnt lgkmcnt(8)
    v_mfma_f32_32x32x16_bf16 v[128:143], v[20:23], v[196:199], v[128:143]
    v_cvt_pk_bf16_f32 v216, v160, v161
    v_lshlrev_b32 v160, 16, v216
    v_and_b32 v161, 0xffff0000, v216
    v_mul_f32 v216, s90, v160
    v_mul_f32 v217, s90, v161
    v_exp_f32 v216, v216
    v_exp_f32 v217, v217
    ds_read_b64_tr_b16 v[192:193], v2 offset:6144
    ds_read_b64_tr_b16 v[194:195], v2 offset:6400
    s_waitcnt lgkmcnt(8)
    v_mfma_f32_32x32x16_bf16 v[128:143], v[24:27], v[200:203], v[128:143]
    v_add_f32 v218, 1.0, v160
    v_add_f32 v219, 1.0, v161
    v_cmp_lt_f32 vcc, 0, v160
    s_nop 1
    v_cndmask_b32 v160, v216, v218, vcc
    v_cmp_lt_f32 vcc, 0, v161
    s_nop 1
    ds_read_b64_tr_b16 v[196:197], v2 offset:7168
    ds_read_b64_tr_b16 v[198:199], v2 offset:7424
    s_waitcnt lgkmcnt(8)
    v_mfma_f32_32x32x16_bf16 v[128:143], v[28:31], v[204:207], v[128:143]
    v_cndmask_b32 v161, v217, v219, vcc
    v_cvt_pk_bf16_f32 v216, v160, v161
    v_lshlrev_b32 v160, 16, v216
    v_and_b32 v161, 0xffff0000, v216
    v_add_f32 v160, s91, v160
    v_add_f32 v161, s91, v161
    v_cvt_pk_bf16_f32 v224, v160, v161
    ds_read_b64_tr_b16 v[200:201], v2 offset:8192
    ds_read_b64_tr_b16 v[202:203], v2 offset:8448
    s_waitcnt lgkmcnt(8)
    v_mfma_f32_32x32x16_bf16 v[128:143], v[32:35], v[208:211], v[128:143]
    v_cvt_pk_bf16_f32 v216, v162, v163
    v_lshlrev_b32 v162, 16, v216
    v_and_b32 v163, 0xffff0000, v216
    v_mul_f32 v216, s90, v162
    v_mul_f32 v217, s90, v163
    v_exp_f32 v216, v216
    v_exp_f32 v217, v217
    ds_read_b64_tr_b16 v[204:205], v2 offset:9216
    ds_read_b64_tr_b16 v[206:207], v2 offset:9472
    s_waitcnt lgkmcnt(8)
    v_mfma_f32_32x32x16_bf16 v[128:143], v[36:39], v[212:215], v[128:143]
    v_add_f32 v218, 1.0, v162
    v_add_f32 v219, 1.0, v163
    v_cmp_lt_f32 vcc, 0, v162
    s_nop 1
    v_cndmask_b32 v162, v216, v218, vcc
    v_cmp_lt_f32 vcc, 0, v163
    s_nop 1
    ds_read_b64_tr_b16 v[208:209], v2 offset:10240
    ds_read_b64_tr_b16 v[210:211], v2 offset:10496
    s_waitcnt lgkmcnt(8)
    v_mfma_f32_32x32x16_bf16 v[128:143], v[40:43], v[192:195], v[128:143]
    v_cndmask_b32 v163, v217, v219, vcc
    v_cvt_pk_bf16_f32 v216, v162, v163
    v_lshlrev_b32 v162, 16, v216
    v_and_b32 v163, 0xffff0000, v216
    v_add_f32 v162, s91, v162
    v_add_f32 v163, s91, v163
    v_cvt_pk_bf16_f32 v225, v162, v163
    ds_read_b64_tr_b16 v[212:213], v2 offset:11264
    ds_read_b64_tr_b16 v[214:215], v2 offset:11520
    s_waitcnt lgkmcnt(8)
    v_mfma_f32_32x32x16_bf16 v[128:143], v[44:47], v[196:199], v[128:143]
    v_cvt_pk_bf16_f32 v216, v164, v165
    v_lshlrev_b32 v164, 16, v216
    v_and_b32 v165, 0xffff0000, v216
    v_mul_f32 v216, s90, v164
    v_mul_f32 v217, s90, v165
    v_exp_f32 v216, v216
    v_exp_f32 v217, v217
    ds_read_b64_tr_b16 v[192:193], v2 offset:12288
    ds_read_b64_tr_b16 v[194:195], v2 offset:12544
    s_waitcnt lgkmcnt(8)
    v_mfma_f32_32x32x16_bf16 v[128:143], v[48:51], v[200:203], v[128:143]
    v_add_f32 v218, 1.0, v164
    v_add_f32 v219, 1.0, v165
    v_cmp_lt_f32 vcc, 0, v164
    s_nop 1
    v_cndmask_b32 v164, v216, v218, vcc
    v_cmp_lt_f32 vcc, 0, v165
    s_nop 1
    ds_read_b64_tr_b16 v[196:197], v2 offset:13312
    ds_read_b64_tr_b16 v[198:199], v2 offset:13568
    s_waitcnt lgkmcnt(8)
    v_mfma_f32_32x32x16_bf16 v[128:143], v[52:55], v[204:207], v[128:143]
    v_cndmask_b32 v165, v217, v219, vcc
    v_cvt_pk_bf16_f32 v216, v164, v165
    v_lshlrev_b32 v164, 16, v216
    v_and_b32 v165, 0xffff0000, v216
    v_add_f32 v164, s91, v164
    v_add_f32 v165, s91, v165
    v_cvt_pk_bf16_f32 v226, v164, v165
    ds_read_b64_tr_b16 v[200:201], v2 offset:14336
    ds_read_b64_tr_b16 v[202:203], v2 offset:14592
    s_waitcnt lgkmcnt(8)
    v_mfma_f32_32x32x16_bf16 v[128:143], v[56:59], v[208:211], v[128:143]
    v_cvt_pk_bf16_f32 v216, v166, v167
    v_lshlrev_b32 v166, 16, v216
    v_and_b32 v167, 0xffff0000, v216
    v_mul_f32 v216, s90, v166
    v_mul_f32 v217, s90, v167
    v_exp_f32 v216, v216
    v_exp_f32 v217, v217
    ds_read_b64_tr_b16 v[204:205], v2 offset:15360
    ds_read_b64_tr_b16 v[206:207], v2 offset:15616
    s_waitcnt lgkmcnt(8)
    v_mfma_f32_32x32x16_bf16 v[128:143], v[60:63], v[212:215], v[128:143]
    v_add_f32 v218, 1.0, v166
    v_add_f32 v219, 1.0, v167
    v_cmp_lt_f32 vcc, 0, v166
    s_nop 1
    v_cndmask_b32 v166, v216, v218, vcc
    v_cmp_lt_f32 vcc, 0, v167
    s_nop 1
    ds_read_b64_tr_b16 v[208:209], v2 offset:16384
    ds_read_b64_tr_b16 v[210:211], v2 offset:16640
    s_waitcnt lgkmcnt(8)
    v_mfma_f32_32x32x16_bf16 v[128:143], v[64:67], v[192:195], v[128:143]
    v_cndmask_b32 v167, v217, v219, vcc
    v_cvt_pk_bf16_f32 v216, v166, v167
    v_lshlrev_b32 v166, 16, v216
    v_and_b32 v167, 0xffff0000, v216
    v_add_f32 v166, s91, v166
    v_add_f32 v167, s91, v167
    v_cvt_pk_bf16_f32 v227, v166, v167
    ds_read_b64_tr_b16 v[212:213], v2 offset:17408
    ds_read_b64_tr_b16 v[214:215], v2 offset:17664
    s_waitcnt lgkmcnt(8)
    v_mfma_f32_32x32x16_bf16 v[128:143], v[68:71], v[196:199], v[128:143]
    v_cvt_pk_bf16_f32 v216, v168, v169
    v_lshlrev_b32 v168, 16, v216
    v_and_b32 v169, 0xffff0000, v216
    v_mul_f32 v216, s90, v168
    v_mul_f32 v217, s90, v169
    v_exp_f32 v216, v216
    v_exp_f32 v217, v217
    ds_read_b64_tr_b16 v[192:193], v2 offset:18432
    ds_read_b64_tr_b16 v[194:195], v2 offset:18688
    s_waitcnt lgkmcnt(8)
    v_mfma_f32_32x32x16_bf16 v[128:143], v[72:75], v[200:203], v[128:143]
    v_add_f32 v218, 1.0, v168
    v_add_f32 v219, 1.0, v169
    v_cmp_lt_f32 vcc, 0, v168
    s_nop 1
    v_cndmask_b32 v168, v216, v218, vcc
    v_cmp_lt_f32 vcc, 0, v169
    s_nop 1
    ds_read_b64_tr_b16 v[196:197], v2 offset:19456
    ds_read_b64_tr_b16 v[198:199], v2 offset:19712
    s_waitcnt lgkmcnt(8)
    v_mfma_f32_32x32x16_bf16 v[128:143], v[76:79], v[204:207], v[128:143]
    v_cndmask_b32 v169, v217, v219, vcc
    v_cvt_pk_bf16_f32 v216, v168, v169
    v_lshlrev_b32 v168, 16, v216
    v_and_b32 v169, 0xffff0000, v216
    v_add_f32 v168, s91, v168
    v_add_f32 v169, s91, v169
    v_cvt_pk_bf16_f32 v228, v168, v169
    ds_read_b64_tr_b16 v[200:201], v2 offset:20480
    ds_read_b64_tr_b16 v[202:203], v2 offset:20736
    s_waitcnt lgkmcnt(8)
    v_mfma_f32_32x32x16_bf16 v[128:143], v[80:83], v[208:211], v[128:143]
    v_cvt_pk_bf16_f32 v216, v170, v171
    v_lshlrev_b32 v170, 16, v216
    v_and_b32 v171, 0xffff0000, v216
    v_mul_f32 v216, s90, v170
    v_mul_f32 v217, s90, v171
    v_exp_f32 v216, v216
    v_exp_f32 v217, v217
    ds_read_b64_tr_b16 v[204:205], v2 offset:21504
    ds_read_b64_tr_b16 v[206:207], v2 offset:21760
    s_waitcnt lgkmcnt(8)
    v_mfma_f32_32x32x16_bf16 v[128:143], v[84:87], v[212:215], v[128:143]
    v_add_f32 v218, 1.0, v170
    v_add_f32 v219, 1.0, v171
    v_cmp_lt_f32 vcc, 0, v170
    s_nop 1
    v_cndmask_b32 v170, v216, v218, vcc
    v_cmp_lt_f32 vcc, 0, v171
    s_nop 1
    ds_read_b64_tr_b16 v[208:209], v2 offset:22528
    ds_read_b64_tr_b16 v[210:211], v2 offset:22784
    s_waitcnt lgkmcnt(8)
    v_mfma_f32_32x32x16_bf16 v[128:143], v[88:91], v[192:195], v[128:143]
    v_cndmask_b32 v171, v217, v219, vcc
    v_cvt_pk_bf16_f32 v216, v170, v171
    v_lshlrev_b32 v170, 16, v216
    v_and_b32 v171, 0xffff0000, v216
    v_add_f32 v170, s91, v170
    v_add_f32 v171, s91, v171
    v_cvt_pk_bf16_f32 v229, v170, v171
    ds_read_b64_tr_b16 v[212:213], v2 offset:23552
    ds_read_b64_tr_b16 v[214:215], v2 offset:23808
    s_waitcnt lgkmcnt(8)
    v_mfma_f32_32x32x16_bf16 v[128:143], v[92:95], v[196:199], v[128:143]
    v_cvt_pk_bf16_f32 v216, v172, v173
    v_lshlrev_b32 v172, 16, v216
    v_and_b32 v173, 0xffff0000, v216
    v_mul_f32 v216, s90, v172
    v_mul_f32 v217, s90, v173
    v_exp_f32 v216, v216
    v_exp_f32 v217, v217
    ds_read_b64_tr_b16 v[192:193], v2 offset:24576
    ds_read_b64_tr_b16 v[194:195], v2 offset:24832
    s_waitcnt lgkmcnt(8)
    v_mfma_f32_32x32x16_bf16 v[128:143], v[96:99], v[200:203], v[128:143]
    v_add_f32 v218, 1.0, v172
    v_add_f32 v219, 1.0, v173
    v_cmp_lt_f32 vcc, 0, v172
    s_nop 1
    v_cndmask_b32 v172, v216, v218, vcc
    v_cmp_lt_f32 vcc, 0, v173
    s_nop 1
    ds_read_b64_tr_b16 v[196:197], v2 offset:25600
    ds_read_b64_tr_b16 v[198:199], v2 offset:25856
    s_waitcnt lgkmcnt(8)
    v_mfma_f32_32x32x16_bf16 v[128:143], v[100:103], v[204:207], v[128:143]
    v_cndmask_b32 v173, v217, v219, vcc
    v_cvt_pk_bf16_f32 v216, v172, v173
    v_lshlrev_b32 v172, 16, v216
    v_and_b32 v173, 0xffff0000, v216
    v_add_f32 v172, s91, v172
    v_add_f32 v173, s91, v173
    v_cvt_pk_bf16_f32 v230, v172, v173
    ds_read_b64_tr_b16 v[200:201], v2 offset:26624
    ds_read_b64_tr_b16 v[202:203], v2 offset:26880
    s_waitcnt lgkmcnt(8)
    v_mfma_f32_32x32x16_bf16 v[128:143], v[104:107], v[208:211], v[128:143]
    v_cvt_pk_bf16_f32 v216, v174, v175
    v_lshlrev_b32 v174, 16, v216
    v_and_b32 v175, 0xffff0000, v216
    v_mul_f32 v216, s90, v174
    v_mul_f32 v217, s90, v175
    v_exp_f32 v216, v216
    v_exp_f32 v217, v217
    ds_read_b64_tr_b16 v[204:205], v2 offset:27648
    ds_read_b64_tr_b16 v[206:207], v2 offset:27904
    s_waitcnt lgkmcnt(8)
    v_mfma_f32_32x32x16_bf16 v[128:143], v[108:111], v[212:215], v[128:143]
    v_add_f32 v218, 1.0, v174
    v_add_f32 v219, 1.0, v175
    v_cmp_lt_f32 vcc, 0, v174
    s_nop 1
    v_cndmask_b32 v174, v216, v218, vcc
    v_cmp_lt_f32 vcc, 0, v175
    s_nop 1
    s_waitcnt lgkmcnt(6)
    v_mfma_f32_32x32x16_bf16 v[128:143], v[112:115], v[192:195], v[128:143]
    v_cndmask_b32 v175, v217, v219, vcc
    v_cvt_pk_bf16_f32 v216, v174, v175
    v_lshlrev_b32 v174, 16, v216
    v_and_b32 v175, 0xffff0000, v216
    v_add_f32 v174, s91, v174
    v_add_f32 v175, s91, v175
    v_cvt_pk_bf16_f32 v231, v174, v175
    s_waitcnt lgkmcnt(4)
    v_mfma_f32_32x32x16_bf16 v[128:143], v[116:119], v[196:199], v[128:143]
    v_cmp_gt_u32 vcc, 28, v3
    s_nop 1
    v_cndmask_b32 v224, 0, v224, vcc
    v_cndmask_b32 v225, 0, v225, vcc
    v_cndmask_b32 v226, 0, v226, vcc
    v_cndmask_b32 v227, 0, v227, vcc
    v_cndmask_b32 v228, 0, v228, vcc
    s_waitcnt lgkmcnt(2)
    v_mfma_f32_32x32x16_bf16 v[128:143], v[120:123], v[200:203], v[128:143]
    v_cndmask_b32 v229, 0, v229, vcc
    v_cndmask_b32 v230, 0, v230, vcc
    v_cndmask_b32 v231, 0, v231, vcc
    s_waitcnt lgkmcnt(0)
    v_mfma_f32_32x32x16_bf16 v[128:143], v[124:127], v[204:207], v[128:143]
    s_waitcnt vmcnt(0)
    s_waitcnt lgkmcnt(0)
    s_barrier
    s_mul_i32 s39, s5, 229376
    s_add_u32 s39, s39, 16805888
    s_add_u32 s38, s6, 0
    s_lshl_b32 s38, s38, 10
    s_add_u32 s30, s38, 0
    s_mov_b32 m0, s30
    s_add_u32 s30, s38, s39
    buffer_load_dwordx4 v5, s[24:27], s30 offen lds
    s_add_u32 s38, s6, 8
    s_lshl_b32 s38, s38, 10
    s_add_u32 s30, s38, 0
    s_mov_b32 m0, s30
    s_add_u32 s30, s38, s39
    buffer_load_dwordx4 v5, s[24:27], s30 offen lds
    s_add_u32 s38, s6, 16
    s_lshl_b32 s38, s38, 10
    s_add_u32 s30, s38, 0
    s_mov_b32 m0, s30
    s_add_u32 s30, s38, s39
    buffer_load_dwordx4 v5, s[24:27], s30 offen lds
    s_and_b32 s38, s6, 3
    s_add_u32 s38, s38, 24
    s_lshl_b32 s38, s38, 10
    s_add_u32 s30, s38, 0
    s_mov_b32 m0, s30
    s_add_u32 s30, s38, s39
    buffer_load_dwordx4 v5, s[24:27], s30 offen lds
    v_mov_b32 v160, 0
    v_mov_b32 v161, 0
    v_mov_b32 v162, 0
    v_mov_b32 v163, 0
    v_mov_b32 v164, 0
    v_mov_b32 v165, 0
    v_mov_b32 v166, 0
    v_mov_b32 v167, 0
    v_mov_b32 v168, 0
    v_mov_b32 v169, 0
    v_mov_b32 v170, 0
    v_mov_b32 v171, 0
    v_mov_b32 v172, 0
    v_mov_b32 v173, 0
    v_mov_b32 v174, 0
    v_mov_b32 v175, 0
    v_add_u32 v2, 28672, v6
    ds_read_b64_tr_b16 v[192:193], v2 offset:0
    ds_read_b64_tr_b16 v[194:195], v2 offset:256
    ds_read_b64_tr_b16 v[196:197], v2 offset:1024
    ds_read_b64_tr_b16 v[198:199], v2 offset:1280
    ds_read_b64_tr_b16 v[200:201], v2 offset:2048
    ds_read_b64_tr_b16 v[202:203], v2 offset:2304
    ds_read_b64_tr_b16 v[204:205], v2 offset:3072
    ds_read_b64_tr_b16 v[206:207], v2 offset:3328
    ds_read_b64_tr_b16 v[208:209], v2 offset:4096
    ds_read_b64_tr_b16 v[210:211], v2 offset:4352
    s_waitcnt lgkmcnt(8)
    v_mfma_f32_32x32x16_bf16 v[160:175], v[192:195], v[16:19], v[160:175]
    ds_read_b64_tr_b16 v[212:213], v2 offset:5120
    ds_read_b64_tr_b16 v[214:215], v2 offset:5376
    s_waitcnt lgkmcnt(8)
    v_mfma_f32_32x32x16_bf16 v[160:175], v[196:199], v[20:23], v[160:175]
    v_cvt_pk_bf16_f32 v232, v128, v129
    v_cvt_pk_bf16_f32 v233, v130, v131
    ds_read_b64_tr_b16 v[192:193], v2 offset:6144
    ds_read_b64_tr_b16 v[194:195], v2 offset:6400
    s_waitcnt lgkmcnt(8)
    v_mfma_f32_32x32x16_bf16 v[160:175], v[200:203], v[24:27], v[160:175]
    v_cvt_pk_bf16_f32 v234, v132, v133
    v_cvt_pk_bf16_f32 v235, v134, v135
    ds_read_b64_tr_b16 v[196:197], v2 offset:7168
    ds_read_b64_tr_b16 v[198:199], v2 offset:7424
    s_waitcnt lgkmcnt(8)
    v_mfma_f32_32x32x16_bf16 v[160:175], v[204:207], v[28:31], v[160:175]
    v_cvt_pk_bf16_f32 v236, v136, v137
    v_cvt_pk_bf16_f32 v237, v138, v139
    ds_read_b64_tr_b16 v[200:201], v2 offset:8192
    ds_read_b64_tr_b16 v[202:203], v2 offset:8448
    s_waitcnt lgkmcnt(8)
    v_mfma_f32_32x32x16_bf16 v[160:175], v[208:211], v[32:35], v[160:175]
    v_cvt_pk_bf16_f32 v238, v140, v141
    v_cvt_pk_bf16_f32 v239, v142, v143
    ds_read_b64_tr_b16 v[204:205], v2 offset:9216
    ds_read_b64_tr_b16 v[206:207], v2 offset:9472
    s_waitcnt lgkmcnt(8)
    v_mfma_f32_32x32x16_bf16 v[160:175], v[212:215], v[36:39], v[160:175]
    v_cmp_eq_u32 vcc, 28, v3
    v_mov_b32 v216, 0x3f803f80
    ds_read_b64_tr_b16 v[208:209], v2 offset:10240
    ds_read_b64_tr_b16 v[210:211], v2 offset:10496
    s_waitcnt lgkmcnt(8)
    v_mfma_f32_32x32x16_bf16 v[160:175], v[192:195], v[40:43], v[160:175]
    s_nop 1
    v_cndmask_b32 v232, v232, v216, vcc
    ds_read_b64_tr_b16 v[212:213], v2 offset:11264
    ds_read_b64_tr_b16 v[214:215], v2 offset:11520
    s_waitcnt lgkmcnt(8)
    v_mfma_f32_32x32x16_bf16 v[160:175], v[196:199], v[44:47], v[160:175]
    v_cndmask_b32 v233, v233, v216, vcc
    v_cndmask_b32 v234, v234, v216, vcc
    ds_read_b64_tr_b16 v[192:193], v2 offset:12288
    ds_read_b64_tr_b16 v[194:195], v2 offset:12544
    s_waitcnt lgkmcnt(8)
    v_mfma_f32_32x32x16_bf16 v[160:175], v[200:203], v[48:51], v[160:175]
    v_cndmask_b32 v235, v235, v216, vcc
    v_cndmask_b32 v236, v236, v216, vcc
    ds_read_b64_tr_b16 v[196:197], v2 offset:13312
    ds_read_b64_tr_b16 v[198:199], v2 offset:13568
    s_waitcnt lgkmcnt(8)
    v_mfma_f32_32x32x16_bf16 v[160:175], v[204:207], v[52:55], v[160:175]
    v_cndmask_b32 v237, v237, v216, vcc
    v_cndmask_b32 v238, v238, v216, vcc
    ds_read_b64_tr_b16 v[200:201], v2 offset:14336
    ds_read_b64_tr_b16 v[202:203], v2 offset:14592
    s_waitcnt lgkmcnt(8)
    v_mfma_f32_32x32x16_bf16 v[160:175], v[208:211], v[56:59], v[160:175]
    v_cndmask_b32 v239, v239, v216, vcc
    v_mov_b32 v240, 0
    ds_read_b64_tr_b16 v[204:205], v2 offset:15360
    ds_read_b64_tr_b16 v[206:207], v2 offset:15616
    s_waitcnt lgkmcnt(8)
    v_mfma_f32_32x32x16_bf16 v[160:175], v[212:215], v[60:63], v[160:175]
    v_mov_b32 v241, 0
    v_mov_b32 v242, 0
    ds_read_b64_tr_b16 v[208:209], v2 offset:16384
    ds_read_b64_tr_b16 v[210:211], v2 offset:16640
    s_waitcnt lgkmcnt(8)
    v_mfma_f32_32x32x16_bf16 v[160:175], v[192:195], v[64:67], v[160:175]
    v_mov_b32 v243, 0
    v_mov_b32 v244, 0
    ds_read_b64_tr_b16 v[212:213], v2 offset:17408
    ds_read_b64_tr_b16 v[214:215], v2 offset:17664
    s_waitcnt lgkmcnt(8)
    v_mfma_f32_32x32x16_bf16 v[160:175], v[196:199], v[68:71], v[160:175]
    v_mov_b32 v245, 0
    v_mov_b32 v246, 0
    ds_read_b64_tr_b16 v[192:193], v2 offset:18432
    ds_read_b64_tr_b16 v[194:195], v2 offset:18688
    s_waitcnt lgkmcnt(8)
    v_mfma_f32_32x32x16_bf16 v[160:175], v[200:203], v[72:75], v[160:175]
    v_mov_b32 v247, 0
    v_mov_b32 v248, 0
    ds_read_b64_tr_b16 v[196:197], v2 offset:19456
    ds_read_b64_tr_b16 v[198:199], v2 offset:19712
    s_waitcnt lgkmcnt(8)
    v_mfma_f32_32x32x16_bf16 v[160:175], v[204:207], v[76:79], v[160:175]
    v_mov_b32 v249, 0
    v_mov_b32 v250, 0
    ds_read_b64_tr_b16 v[200:201], v2 offset:20480
    ds_read_b64_tr_b16 v[202:203], v2 offset:20736
    s_waitcnt lgkmcnt(8)
    v_mfma_f32_32x32x16_bf16 v[160:175], v[208:211], v[80:83], v[160:175]
    v_mov_b32 v251, 0
    v_mov_b32 v252, 0
    ds_read_b64_tr_b16 v[204:205], v2 offset:21504
    ds_read_b64_tr_b16 v[206:207], v2 offset:21760
    s_waitcnt lgkmcnt(8)
    v_mfma_f32_32x32x16_bf16 v[160:175], v[212:215], v[84:87], v[160:175]
    v_mov_b32 v253, 0
    v_mov_b32 v254, 0
    ds_read_b64_tr_b16 v[208:209], v2 offset:22528
    ds_read_b64_tr_b16 v[210:211], v2 offset:22784
    s_waitcnt lgkmcnt(8)
    v_mfma_f32_32x32x16_bf16 v[160:175], v[192:195], v[88:91], v[160:175]
    v_mov_b32 v255, 0
    s_nop 1
    ds_read_b64_tr_b16 v[212:213], v2 offset:23552
    ds_read_b64_tr_b16 v[214:215], v2 offset:23808
    s_waitcnt lgkmcnt(8)
    v_mfma_f32_32x32x16_bf16 v[160:175], v[196:199], v[92:95], v[160:175]
    v_mfma_f32_32x32x16_bf16 v[240:255], v[224:227], v[232:235], v[240:255]
    v_mfma_f32_32x32x16_bf16 v[240:255], v[228:231], v[236:239], v[240:255]
    ds_read_b64_tr_b16 v[192:193], v2 offset:24576
    ds_read_b64_tr_b16 v[194:195], v2 offset:24832
    s_waitcnt lgkmcnt(8)
    v_mfma_f32_32x32x16_bf16 v[160:175], v[200:203], v[96:99], v[160:175]
    s_nop 15
    s_nop 3
    ds_read_b64_tr_b16 v[196:197], v2 offset:25600
    ds_read_b64_tr_b16 v[198:199], v2 offset:25856
    s_waitcnt lgkmcnt(8)
    v_mfma_f32_32x32x16_bf16 v[160:175], v[204:207], v[100:103], v[160:175]
    v_lshlrev_b32 v10, 4, v1
    s_lshl_b32 s36, s6, 12
    ds_read_b64_tr_b16 v[200:201], v2 offset:26624
    ds_read_b64_tr_b16 v[202:203], v2 offset:26880
    s_waitcnt lgkmcnt(8)
    v_mfma_f32_32x32x16_bf16 v[160:175], v[208:211], v[104:107], v[160:175]
    s_add_u32 s36, s36, 57344
    v_add_u32 v10, s36, v10
    ds_read_b64_tr_b16 v[204:205], v2 offset:27648
    ds_read_b64_tr_b16 v[206:207], v2 offset:27904
    s_waitcnt lgkmcnt(8)
    v_mfma_f32_32x32x16_bf16 v[160:175], v[212:215], v[108:111], v[160:175]
    ds_write_b128 v10, v[240:243] offset:0
    ds_write_b128 v10, v[244:247] offset:1024
    s_waitcnt lgkmcnt(6)
    v_mfma_f32_32x32x16_bf16 v[160:175], v[192:195], v[112:115], v[160:175]
    ds_write_b128 v10, v[248:251] offset:2048
    ds_write_b128 v10, v[252:255] offset:3072
    s_waitcnt lgkmcnt(4)
    v_mfma_f32_32x32x16_bf16 v[160:175], v[196:199], v[116:119], v[160:175]
    s_waitcnt lgkmcnt(0)
    s_barrier
    s_waitcnt lgkmcnt(2)
    v_mfma_f32_32x32x16_bf16 v[160:175], v[200:203], v[120:123], v[160:175]
    v_lshlrev_b32 v10, 4, v1
    s_lshr_b32 s36, s6, 1
    s_waitcnt lgkmcnt(0)
    v_mfma_f32_32x32x16_bf16 v[160:175], v[204:207], v[124:127], v[160:175]
    s_lshl_b32 s36, s36, 10
    s_and_b32 s37, s6, 1
    s_waitcnt vmcnt(0)
    s_waitcnt lgkmcnt(0)
    s_barrier
    v_mov_b32 v176, 0
    v_mov_b32 v177, 0
    v_mov_b32 v178, 0
    v_mov_b32 v179, 0
    v_mov_b32 v180, 0
    v_mov_b32 v181, 0
    v_mov_b32 v182, 0
    v_mov_b32 v183, 0
    v_mov_b32 v184, 0
    v_mov_b32 v185, 0
    v_mov_b32 v186, 0
    v_mov_b32 v187, 0
    v_mov_b32 v188, 0
    v_mov_b32 v189, 0
    v_mov_b32 v190, 0
    v_mov_b32 v191, 0
    v_add_u32 v2, 0, v6
    ds_read_b64_tr_b16 v[192:193], v2 offset:0
    ds_read_b64_tr_b16 v[194:195], v2 offset:256
    ds_read_b64_tr_b16 v[196:197], v2 offset:1024
    ds_read_b64_tr_b16 v[198:199], v2 offset:1280
    ds_read_b64_tr_b16 v[200:201], v2 offset:2048
    ds_read_b64_tr_b16 v[202:203], v2 offset:2304
    ds_read_b64_tr_b16 v[204:205], v2 offset:3072
    ds_read_b64_tr_b16 v[206:207], v2 offset:3328
    ds_read_b64_tr_b16 v[208:209], v2 offset:4096
    ds_read_b64_tr_b16 v[210:211], v2 offset:4352
    s_waitcnt lgkmcnt(8)
    v_mfma_f32_32x32x16_bf16 v[176:191], v[192:195], v[16:19], v[176:191]
    ds_read_b64_tr_b16 v[212:213], v2 offset:5120
    ds_read_b64_tr_b16 v[214:215], v2 offset:5376
    s_waitcnt lgkmcnt(8)
    v_mfma_f32_32x32x16_bf16 v[176:191], v[196:199], v[20:23], v[176:191]
    s_lshl_b32 s37, s37, 3
    s_add_u32 s36, s36, s37
    ds_read_b64_tr_b16 v[192:193], v2 offset:6144
    ds_read_b64_tr_b16 v[194:195], v2 offset:6400
    s_waitcnt lgkmcnt(8)
    v_mfma_f32_32x32x16_bf16 v[176:191], v[200:203], v[24:27], v[176:191]
    s_add_u32 s36, s36, 57344
    v_add_u32 v10, s36, v10
    ds_read_b64_tr_b16 v[196:197], v2 offset:7168
    ds_read_b64_tr_b16 v[198:199], v2 offset:7424
    s_waitcnt lgkmcnt(8)
    v_mfma_f32_32x32x16_bf16 v[176:191], v[204:207], v[28:31], v[176:191]
    ds_read_b64 v[240:241], v10 offset:0
    ds_read_b64 v[242:243], v10 offset:4096
    ds_read_b64_tr_b16 v[200:201], v2 offset:8192
    ds_read_b64_tr_b16 v[202:203], v2 offset:8448
    s_waitcnt lgkmcnt(8)
    v_mfma_f32_32x32x16_bf16 v[176:191], v[208:211], v[32:35], v[176:191]
    ds_read_b64 v[244:245], v10 offset:8192
    ds_read_b64 v[246:247], v10 offset:12288
    ds_read_b64_tr_b16 v[204:205], v2 offset:9216
    ds_read_b64_tr_b16 v[206:207], v2 offset:9472
    s_waitcnt lgkmcnt(8)
    v_mfma_f32_32x32x16_bf16 v[176:191], v[212:215], v[36:39], v[176:191]
    ds_read_b64 v[248:249], v10 offset:16384
    ds_read_b64 v[250:251], v10 offset:20480
    ds_read_b64_tr_b16 v[208:209], v2 offset:10240
    ds_read_b64_tr_b16 v[210:211], v2 offset:10496
    s_waitcnt lgkmcnt(8)
    v_mfma_f32_32x32x16_bf16 v[176:191], v[192:195], v[40:43], v[176:191]
    ds_read_b64 v[252:253], v10 offset:24576
    ds_read_b64 v[254:255], v10 offset:28672
    ds_read_b64_tr_b16 v[212:213], v2 offset:11264
    ds_read_b64_tr_b16 v[214:215], v2 offset:11520
    s_waitcnt lgkmcnt(8)
    v_mfma_f32_32x32x16_bf16 v[176:191], v[196:199], v[44:47], v[176:191]
    s_waitcnt lgkmcnt(0)
    v_add_f32 v240, v240, v242
    ds_read_b64_tr_b16 v[192:193], v2 offset:12288
    ds_read_b64_tr_b16 v[194:195], v2 offset:12544
    s_waitcnt lgkmcnt(8)
    v_mfma_f32_32x32x16_bf16 v[176:191], v[200:203], v[48:51], v[176:191]
    v_add_f32 v241, v241, v243
    v_add_f32 v240, v240, v244
    ds_read_b64_tr_b16 v[196:197], v2 offset:13312
    ds_read_b64_tr_b16 v[198:199], v2 offset:13568
    s_waitcnt lgkmcnt(8)
    v_mfma_f32_32x32x16_bf16 v[176:191], v[204:207], v[52:55], v[176:191]
    v_add_f32 v241, v241, v245
    v_add_f32 v240, v240, v246
    ds_read_b64_tr_b16 v[200:201], v2 offset:14336
    ds_read_b64_tr_b16 v[202:203], v2 offset:14592
    s_waitcnt lgkmcnt(8)
    v_mfma_f32_32x32x16_bf16 v[176:191], v[208:211], v[56:59], v[176:191]
    v_add_f32 v241, v241, v247
    v_add_f32 v240, v240, v248
    ds_read_b64_tr_b16 v[204:205], v2 offset:15360
    ds_read_b64_tr_b16 v[206:207], v2 offset:15616
    s_waitcnt lgkmcnt(8)
    v_mfma_f32_32x32x16_bf16 v[176:191], v[212:215], v[60:63], v[176:191]
    v_add_f32 v241, v241, v249
    v_add_f32 v240, v240, v250
    ds_read_b64_tr_b16 v[208:209], v2 offset:16384
    ds_read_b64_tr_b16 v[210:211], v2 offset:16640
    s_waitcnt lgkmcnt(8)
    v_mfma_f32_32x32x16_bf16 v[176:191], v[192:195], v[64:67], v[176:191]
    v_add_f32 v241, v241, v251
    v_add_f32 v240, v240, v252
    ds_read_b64_tr_b16 v[212:213], v2 offset:17408
    ds_read_b64_tr_b16 v[214:215], v2 offset:17664
    s_waitcnt lgkmcnt(8)
    v_mfma_f32_32x32x16_bf16 v[176:191], v[196:199], v[68:71], v[176:191]
    v_add_f32 v241, v241, v253
    v_add_f32 v240, v240, v254
    ds_read_b64_tr_b16 v[192:193], v2 offset:18432
    ds_read_b64_tr_b16 v[194:195], v2 offset:18688
    s_waitcnt lgkmcnt(8)
    v_mfma_f32_32x32x16_bf16 v[176:191], v[200:203], v[72:75], v[176:191]
    v_add_f32 v241, v241, v255
    v_lshlrev_b32 v10, 6, v1
    ds_read_b64_tr_b16 v[196:197], v2 offset:19456
    ds_read_b64_tr_b16 v[198:199], v2 offset:19712
    s_waitcnt lgkmcnt(8)
    v_mfma_f32_32x32x16_bf16 v[176:191], v[204:207], v[76:79], v[176:191]
    s_lshl_b32 s36, s4, 16
    s_lshl_b32 s37, s5, 12
    ds_read_b64_tr_b16 v[200:201], v2 offset:20480
    ds_read_b64_tr_b16 v[202:203], v2 offset:20736
    s_waitcnt lgkmcnt(8)
    v_mfma_f32_32x32x16_bf16 v[176:191], v[208:211], v[80:83], v[176:191]
    s_add_u32 s36, s36, s37
    s_lshl_b32 s37, s6, 3
    ds_read_b64_tr_b16 v[204:205], v2 offset:21504
    ds_read_b64_tr_b16 v[206:207], v2 offset:21760
    s_waitcnt lgkmcnt(8)
    v_mfma_f32_32x32x16_bf16 v[176:191], v[212:215], v[84:87], v[176:191]
    s_add_u32 s36, s36, s37
    s_add_u32 s36, s36, 10485760
    ds_read_b64_tr_b16 v[208:209], v2 offset:22528
    ds_read_b64_tr_b16 v[210:211], v2 offset:22784
    s_waitcnt lgkmcnt(8)
    v_mfma_f32_32x32x16_bf16 v[176:191], v[192:195], v[88:91], v[176:191]
    buffer_store_dwordx2 v[240:241], v10, s[24:27], s36 offen sc0 sc1
    s_nop 1
    ds_read_b64_tr_b16 v[212:213], v2 offset:23552
    ds_read_b64_tr_b16 v[214:215], v2 offset:23808
    s_waitcnt lgkmcnt(8)
    v_mfma_f32_32x32x16_bf16 v[176:191], v[196:199], v[92:95], v[176:191]
    ds_read_b64_tr_b16 v[192:193], v2 offset:24576
    ds_read_b64_tr_b16 v[194:195], v2 offset:24832
    s_waitcnt lgkmcnt(8)
    v_mfma_f32_32x32x16_bf16 v[176:191], v[200:203], v[96:99], v[176:191]
    ds_read_b64_tr_b16 v[196:197], v2 offset:25600
    ds_read_b64_tr_b16 v[198:199], v2 offset:25856
    s_waitcnt lgkmcnt(8)
    v_mfma_f32_32x32x16_bf16 v[176:191], v[204:207], v[100:103], v[176:191]
    ds_read_b64_tr_b16 v[200:201], v2 offset:26624
    ds_read_b64_tr_b16 v[202:203], v2 offset:26880
    s_waitcnt lgkmcnt(8)
    v_mfma_f32_32x32x16_bf16 v[176:191], v[208:211], v[104:107], v[176:191]
    ds_read_b64_tr_b16 v[204:205], v2 offset:27648
    ds_read_b64_tr_b16 v[206:207], v2 offset:27904
    s_waitcnt lgkmcnt(8)
    v_mfma_f32_32x32x16_bf16 v[176:191], v[212:215], v[108:111], v[176:191]
    s_waitcnt lgkmcnt(6)
    v_mfma_f32_32x32x16_bf16 v[176:191], v[192:195], v[112:115], v[176:191]
    s_waitcnt lgkmcnt(4)
    v_mfma_f32_32x32x16_bf16 v[176:191], v[196:199], v[116:119], v[176:191]
    s_waitcnt lgkmcnt(2)
    v_mfma_f32_32x32x16_bf16 v[176:191], v[200:203], v[120:123], v[176:191]
    s_waitcnt lgkmcnt(0)
    v_mfma_f32_32x32x16_bf16 v[176:191], v[204:207], v[124:127], v[176:191]
    s_nop 15
    s_nop 3
    v_cvt_pk_bf16_f32 v216, v160, v161
    v_lshlrev_b32 v160, 16, v216
    v_and_b32 v161, 0xffff0000, v216
    v_cvt_pk_bf16_f32 v216, v176, v177
    v_lshlrev_b32 v176, 16, v216
    v_and_b32 v177, 0xffff0000, v216
    v_mul_f32 v216, s92, v160
    v_exp_f32 v216, v216
    s_nop 0
    v_add_f32 v216, 1.0, v216
    v_rcp_f32 v216, v216
    s_nop 0
    v_mul_f32 v160, v160, v216
    v_mul_f32 v217, s92, v161
    v_exp_f32 v217, v217
    s_nop 0
    v_add_f32 v217, 1.0, v217
    v_rcp_f32 v217, v217
    s_nop 0
    v_mul_f32 v161, v161, v217
    v_cvt_pk_bf16_f32 v216, v160, v161
    v_lshlrev_b32 v160, 16, v216
    v_and_b32 v161, 0xffff0000, v216
    v_mul_f32 v160, v160, v176
    v_mul_f32 v161, v161, v177
    v_cvt_pk_bf16_f32 v224, v160, v161
    v_cvt_pk_bf16_f32 v216, v162, v163
    v_lshlrev_b32 v162, 16, v216
    v_and_b32 v163, 0xffff0000, v216
    v_cvt_pk_bf16_f32 v216, v178, v179
    v_lshlrev_b32 v178, 16, v216
    v_and_b32 v179, 0xffff0000, v216
    v_mul_f32 v216, s92, v162
    v_exp_f32 v216, v216
    s_nop 0
    v_add_f32 v216, 1.0, v216
    v_rcp_f32 v216, v216
    s_nop 0
    v_mul_f32 v162, v162, v216
    v_mul_f32 v217, s92, v163
    v_exp_f32 v217, v217
    s_nop 0
    v_add_f32 v217, 1.0, v217
    v_rcp_f32 v217, v217
    s_nop 0
    v_mul_f32 v163, v163, v217
    v_cvt_pk_bf16_f32 v216, v162, v163
    v_lshlrev_b32 v162, 16, v216
    v_and_b32 v163, 0xffff0000, v216
    v_mul_f32 v162, v162, v178
    v_mul_f32 v163, v163, v179
    v_cvt_pk_bf16_f32 v225, v162, v163
    v_cvt_pk_bf16_f32 v216, v164, v165
    v_lshlrev_b32 v164, 16, v216
    v_and_b32 v165, 0xffff0000, v216
    v_cvt_pk_bf16_f32 v216, v180, v181
    v_lshlrev_b32 v180, 16, v216
    v_and_b32 v181, 0xffff0000, v216
    v_mul_f32 v216, s92, v164
    v_exp_f32 v216, v216
    s_nop 0
    v_add_f32 v216, 1.0, v216
    v_rcp_f32 v216, v216
    s_nop 0
    v_mul_f32 v164, v164, v216
    v_mul_f32 v217, s92, v165
    v_exp_f32 v217, v217
    s_nop 0
    v_add_f32 v217, 1.0, v217
    v_rcp_f32 v217, v217
    s_nop 0
    v_mul_f32 v165, v165, v217
    v_cvt_pk_bf16_f32 v216, v164, v165
    v_lshlrev_b32 v164, 16, v216
    v_and_b32 v165, 0xffff0000, v216
    v_mul_f32 v164, v164, v180
    v_mul_f32 v165, v165, v181
    v_cvt_pk_bf16_f32 v226, v164, v165
    v_cvt_pk_bf16_f32 v216, v166, v167
    v_lshlrev_b32 v166, 16, v216
    v_and_b32 v167, 0xffff0000, v216
    v_cvt_pk_bf16_f32 v216, v182, v183
    v_lshlrev_b32 v182, 16, v216
    v_and_b32 v183, 0xffff0000, v216
    v_mul_f32 v216, s92, v166
    v_exp_f32 v216, v216
    s_nop 0
    v_add_f32 v216, 1.0, v216
    v_rcp_f32 v216, v216
    s_nop 0
    v_mul_f32 v166, v166, v216
    v_mul_f32 v217, s92, v167
    v_exp_f32 v217, v217
    s_nop 0
    v_add_f32 v217, 1.0, v217
    v_rcp_f32 v217, v217
    s_nop 0
    v_mul_f32 v167, v167, v217
    v_cvt_pk_bf16_f32 v216, v166, v167
    v_lshlrev_b32 v166, 16, v216
    v_and_b32 v167, 0xffff0000, v216
    v_mul_f32 v166, v166, v182
    v_mul_f32 v167, v167, v183
    v_cvt_pk_bf16_f32 v227, v166, v167
    v_cvt_pk_bf16_f32 v216, v168, v169
    v_lshlrev_b32 v168, 16, v216
    v_and_b32 v169, 0xffff0000, v216
    v_cvt_pk_bf16_f32 v216, v184, v185
    v_lshlrev_b32 v184, 16, v216
    v_and_b32 v185, 0xffff0000, v216
    v_mul_f32 v216, s92, v168
    v_exp_f32 v216, v216
    s_nop 0
    v_add_f32 v216, 1.0, v216
    v_rcp_f32 v216, v216
    s_nop 0
    v_mul_f32 v168, v168, v216
    v_mul_f32 v217, s92, v169
    v_exp_f32 v217, v217
    s_nop 0
    v_add_f32 v217, 1.0, v217
    v_rcp_f32 v217, v217
    s_nop 0
    v_mul_f32 v169, v169, v217
    v_cvt_pk_bf16_f32 v216, v168, v169
    v_lshlrev_b32 v168, 16, v216
    v_and_b32 v169, 0xffff0000, v216
    v_mul_f32 v168, v168, v184
    v_mul_f32 v169, v169, v185
    v_cvt_pk_bf16_f32 v228, v168, v169
    v_cvt_pk_bf16_f32 v216, v170, v171
    v_lshlrev_b32 v170, 16, v216
    v_and_b32 v171, 0xffff0000, v216
    v_cvt_pk_bf16_f32 v216, v186, v187
    v_lshlrev_b32 v186, 16, v216
    v_and_b32 v187, 0xffff0000, v216
    v_mul_f32 v216, s92, v170
    v_exp_f32 v216, v216
    s_nop 0
    v_add_f32 v216, 1.0, v216
    v_rcp_f32 v216, v216
    s_nop 0
    v_mul_f32 v170, v170, v216
    v_mul_f32 v217, s92, v171
    v_exp_f32 v217, v217
    s_nop 0
    v_add_f32 v217, 1.0, v217
    v_rcp_f32 v217, v217
    s_nop 0
    v_mul_f32 v171, v171, v217
    v_cvt_pk_bf16_f32 v216, v170, v171
    v_lshlrev_b32 v170, 16, v216
    v_and_b32 v171, 0xffff0000, v216
    v_mul_f32 v170, v170, v186
    v_mul_f32 v171, v171, v187
    v_cvt_pk_bf16_f32 v229, v170, v171
    v_cvt_pk_bf16_f32 v216, v172, v173
    v_lshlrev_b32 v172, 16, v216
    v_and_b32 v173, 0xffff0000, v216
    v_cvt_pk_bf16_f32 v216, v188, v189
    v_lshlrev_b32 v188, 16, v216
    v_and_b32 v189, 0xffff0000, v216
    v_mul_f32 v216, s92, v172
    v_exp_f32 v216, v216
    s_nop 0
    v_add_f32 v216, 1.0, v216
    v_rcp_f32 v216, v216
    s_nop 0
    v_mul_f32 v172, v172, v216
    v_mul_f32 v217, s92, v173
    v_exp_f32 v217, v217
    s_nop 0
    v_add_f32 v217, 1.0, v217
    v_rcp_f32 v217, v217
    s_nop 0
    v_mul_f32 v173, v173, v217
    v_cvt_pk_bf16_f32 v216, v172, v173
    v_lshlrev_b32 v172, 16, v216
    v_and_b32 v173, 0xffff0000, v216
    v_mul_f32 v172, v172, v188
    v_mul_f32 v173, v173, v189
    v_cvt_pk_bf16_f32 v230, v172, v173
    v_cvt_pk_bf16_f32 v216, v174, v175
    v_lshlrev_b32 v174, 16, v216
    v_and_b32 v175, 0xffff0000, v216
    v_cvt_pk_bf16_f32 v216, v190, v191
    v_lshlrev_b32 v190, 16, v216
    v_and_b32 v191, 0xffff0000, v216
    v_mul_f32 v216, s92, v174
    v_exp_f32 v216, v216
    s_nop 0
    v_add_f32 v216, 1.0, v216
    v_rcp_f32 v216, v216
    s_nop 0
    v_mul_f32 v174, v174, v216
    v_mul_f32 v217, s92, v175
    v_exp_f32 v217, v217
    s_nop 0
    v_add_f32 v217, 1.0, v217
    v_rcp_f32 v217, v217
    s_nop 0
    v_mul_f32 v175, v175, v217
    v_cvt_pk_bf16_f32 v216, v174, v175
    v_lshlrev_b32 v174, 16, v216
    v_and_b32 v175, 0xffff0000, v216
    v_mul_f32 v174, v174, v190
    v_mul_f32 v175, v175, v191
    v_cvt_pk_bf16_f32 v231, v174, v175
    s_movk_i32 s39, 0
    buffer_store_dwordx4 v[224:227], v15, s[24:27], s39 offen
    buffer_store_dwordx4 v[228:231], v15, s[24:27], s39 offen offset:1024
    s_nop 1
    s_waitcnt vmcnt(0)
    s_barrier
    s_cmp_lg_u32 s6, 0
    s_cbranch_scc1 K1_done
    s_load_dwordx2 s[40:41], s[0:1], 64
    s_waitcnt lgkmcnt(0)
    s_lshl_b32 s30, s5, 2
    v_mov_b32 v10, s30
    v_mov_b32 v11, 1
    s_mov_b64 s[42:43], exec
    s_mov_b64 exec, 1
    global_atomic_add v12, v10, v11, s[40:41] sc0 sc1
    s_waitcnt vmcnt(0)
    s_mov_b64 exec, s[42:43]
    s_nop 1
    v_readfirstlane_b32 s30, v12
    s_nop 3
    s_cmp_lg_u32 s30, 7
    s_cbranch_scc1 K1_done
    v_lshlrev_b32 v3, 6, v1
    s_lshl_b32 s30, s5, 12
    s_add_u32 s30, s30, 10485760
    buffer_load_dwordx4 v[128:131], v3, s[24:27], s30 offen offset:0 sc0 sc1
    buffer_load_dwordx4 v[132:135], v3, s[24:27], s30 offen offset:16 sc0 sc1
    buffer_load_dwordx4 v[136:139], v3, s[24:27], s30 offen offset:32 sc0 sc1
    buffer_load_dwordx4 v[140:143], v3, s[24:27], s30 offen offset:48 sc0 sc1
    s_lshl_b32 s30, s5, 12
    s_add_u32 s30, s30, 10551296
    buffer_load_dwordx4 v[144:147], v3, s[24:27], s30 offen offset:0 sc0 sc1
    buffer_load_dwordx4 v[148:151], v3, s[24:27], s30 offen offset:16 sc0 sc1
    buffer_load_dwordx4 v[152:155], v3, s[24:27], s30 offen offset:32 sc0 sc1
    buffer_load_dwordx4 v[156:159], v3, s[24:27], s30 offen offset:48 sc0 sc1
    s_lshl_b32 s30, s5, 12
    s_add_u32 s30, s30, 10616832
    buffer_load_dwordx4 v[160:163], v3, s[24:27], s30 offen offset:0 sc0 sc1
    buffer_load_dwordx4 v[164:167], v3, s[24:27], s30 offen offset:16 sc0 sc1
    buffer_load_dwordx4 v[168:171], v3, s[24:27], s30 offen offset:32 sc0 sc1
    buffer_load_dwordx4 v[172:175], v3, s[24:27], s30 offen offset:48 sc0 sc1
    s_lshl_b32 s30, s5, 12
    s_add_u32 s30, s30, 10682368
    buffer_load_dwordx4 v[176:179], v3, s[24:27], s30 offen offset:0 sc0 sc1
    buffer_load_dwordx4 v[180:183], v3, s[24:27], s30 offen offset:16 sc0 sc1
    buffer_load_dwordx4 v[184:187], v3, s[24:27], s30 offen offset:32 sc0 sc1
    buffer_load_dwordx4 v[188:191], v3, s[24:27], s30 offen offset:48 sc0 sc1
    s_lshl_b32 s30, s5, 12
    s_add_u32 s30, s30, 10747904
    buffer_load_dwordx4 v[192:195], v3, s[24:27], s30 offen offset:0 sc0 sc1
    buffer_load_dwordx4 v[196:199], v3, s[24:27], s30 offen offset:16 sc0 sc1
    buffer_load_dwordx4 v[200:203], v3, s[24:27], s30 offen offset:32 sc0 sc1
    buffer_load_dwordx4 v[204:207], v3, s[24:27], s30 offen offset:48 sc0 sc1
    s_lshl_b32 s30, s5, 12
    s_add_u32 s30, s30, 10813440
    buffer_load_dwordx4 v[208:211], v3, s[24:27], s30 offen offset:0 sc0 sc1
    buffer_load_dwordx4 v[212:215], v3, s[24:27], s30 offen offset:16 sc0 sc1
    buffer_load_dwordx4 v[216:219], v3, s[24:27], s30 offen offset:32 sc0 sc1
    buffer_load_dwordx4 v[220:223], v3, s[24:27], s30 offen offset:48 sc0 sc1
    s_lshl_b32 s30, s5, 12
    s_add_u32 s30, s30, 10878976
    buffer_load_dwordx4 v[224:227], v3, s[24:27], s30 offen offset:0 sc0 sc1
    buffer_load_dwordx4 v[228:231], v3, s[24:27], s30 offen offset:16 sc0 sc1
    buffer_load_dwordx4 v[232:235], v3, s[24:27], s30 offen offset:32 sc0 sc1
    buffer_load_dwordx4 v[236:239], v3, s[24:27], s30 offen offset:48 sc0 sc1
    s_lshl_b32 s30, s5, 12
    s_add_u32 s30, s30, 10944512
    buffer_load_dwordx4 v[240:243], v3, s[24:27], s30 offen offset:0 sc0 sc1
    buffer_load_dwordx4 v[244:247], v3, s[24:27], s30 offen offset:16 sc0 sc1
    buffer_load_dwordx4 v[248:251], v3, s[24:27], s30 offen offset:32 sc0 sc1
    buffer_load_dwordx4 v[252:255], v3, s[24:27], s30 offen offset:48 sc0 sc1
    s_waitcnt vmcnt(0)
    v_add_f32 v128, v128, v144
    v_add_f32 v129, v129, v145
    v_add_f32 v130, v130, v146
    v_add_f32 v131, v131, v147
    v_add_f32 v132, v132, v148
    v_add_f32 v133, v133, v149
    v_add_f32 v134, v134, v150
    v_add_f32 v135, v135, v151
    v_add_f32 v136, v136, v152
    v_add_f32 v137, v137, v153
    v_add_f32 v138, v138, v154
    v_add_f32 v139, v139, v155
    v_add_f32 v140, v140, v156
    v_add_f32 v141, v141, v157
    v_add_f32 v142, v142, v158
    v_add_f32 v143, v143, v159
    v_add_f32 v128, v128, v160
    v_add_f32 v129, v129, v161
    v_add_f32 v130, v130, v162
    v_add_f32 v131, v131, v163
    v_add_f32 v132, v132, v164
    v_add_f32 v133, v133, v165
    v_add_f32 v134, v134, v166
    v_add_f32 v135, v135, v167
    v_add_f32 v136, v136, v168
    v_add_f32 v137, v137, v169
    v_add_f32 v138, v138, v170
    v_add_f32 v139, v139, v171
    v_add_f32 v140, v140, v172
    v_add_f32 v141, v141, v173
    v_add_f32 v142, v142, v174
    v_add_f32 v143, v143, v175
    v_add_f32 v128, v128, v176
    v_add_f32 v129, v129, v177
    v_add_f32 v130, v130, v178
    v_add_f32 v131, v131, v179
    v_add_f32 v132, v132, v180
    v_add_f32 v133, v133, v181
    v_add_f32 v134, v134, v182
    v_add_f32 v135, v135, v183
    v_add_f32 v136, v136, v184
    v_add_f32 v137, v137, v185
    v_add_f32 v138, v138, v186
    v_add_f32 v139, v139, v187
    v_add_f32 v140, v140, v188
    v_add_f32 v141, v141, v189
    v_add_f32 v142, v142, v190
    v_add_f32 v143, v143, v191
    v_add_f32 v128, v128, v192
    v_add_f32 v129, v129, v193
    v_add_f32 v130, v130, v194
    v_add_f32 v131, v131, v195
    v_add_f32 v132, v132, v196
    v_add_f32 v133, v133, v197
    v_add_f32 v134, v134, v198
    v_add_f32 v135, v135, v199
    v_add_f32 v136, v136, v200
    v_add_f32 v137, v137, v201
    v_add_f32 v138, v138, v202
    v_add_f32 v139, v139, v203
    v_add_f32 v140, v140, v204
    v_add_f32 v141, v141, v205
    v_add_f32 v142, v142, v206
    v_add_f32 v143, v143, v207
    v_add_f32 v128, v128, v208
    v_add_f32 v129, v129, v209
    v_add_f32 v130, v130, v210
    v_add_f32 v131, v131, v211
    v_add_f32 v132, v132, v212
    v_add_f32 v133, v133, v213
    v_add_f32 v134, v134, v214
    v_add_f32 v135, v135, v215
    v_add_f32 v136, v136, v216
    v_add_f32 v137, v137, v217
    v_add_f32 v138, v138, v218
    v_add_f32 v139, v139, v219
    v_add_f32 v140, v140, v220
    v_add_f32 v141, v141, v221
    v_add_f32 v142, v142, v222
    v_add_f32 v143, v143, v223
    v_add_f32 v128, v128, v224
    v_add_f32 v129, v129, v225
    v_add_f32 v130, v130, v226
    v_add_f32 v131, v131, v227
    v_add_f32 v132, v132, v228
    v_add_f32 v133, v133, v229
    v_add_f32 v134, v134, v230
    v_add_f32 v135, v135, v231
    v_add_f32 v136, v136, v232
    v_add_f32 v137, v137, v233
    v_add_f32 v138, v138, v234
    v_add_f32 v139, v139, v235
    v_add_f32 v140, v140, v236
    v_add_f32 v141, v141, v237
    v_add_f32 v142, v142, v238
    v_add_f32 v143, v143, v239
    v_add_f32 v128, v128, v240
    v_add_f32 v129, v129, v241
    v_add_f32 v130, v130, v242
    v_add_f32 v131, v131, v243
    v_add_f32 v132, v132, v244
    v_add_f32 v133, v133, v245
    v_add_f32 v134, v134, v246
    v_add_f32 v135, v135, v247
    v_add_f32 v136, v136, v248
    v_add_f32 v137, v137, v249
    v_add_f32 v138, v138, v250
    v_add_f32 v139, v139, v251
    v_add_f32 v140, v140, v252
    v_add_f32 v141, v141, v253
    v_add_f32 v142, v142, v254
    v_add_f32 v143, v143, v255
    v_cvt_pk_bf16_f32 v48, v128, v129
    v_cvt_pk_bf16_f32 v49, v130, v131
    v_cvt_pk_bf16_f32 v50, v132, v133
    v_cvt_pk_bf16_f32 v51, v134, v135
    v_cvt_pk_bf16_f32 v52, v136, v137
    v_cvt_pk_bf16_f32 v53, v138, v139
    v_cvt_pk_bf16_f32 v54, v140, v141
    v_cvt_pk_bf16_f32 v55, v142, v143
    v_lshlrev_b32 v3, 5, v1
    s_lshl_b32 s30, s5, 11
    s_add_u32 s30, s30, 11534336
    buffer_store_dwordx4 v[48:51], v3, s[24:27], s30 offen
    buffer_store_dwordx4 v[52:55], v3, s[24:27], s30 offen offset:16
    s_branch K1_done
K1_typeB:
    s_mul_i32 s39, s5, 229376
    s_add_u32 s39, s39, 16834560
    s_add_u32 s38, s6, 0
    s_lshl_b32 s38, s38, 10
    s_add_u32 s30, s38, 0
    s_mov_b32 m0, s30
    s_add_u32 s30, s38, s39
    buffer_load_dwordx4 v5, s[24:27], s30 offen lds
    s_add_u32 s38, s6, 8
    s_lshl_b32 s38, s38, 10
    s_add_u32 s30, s38, 0
    s_mov_b32 m0, s30
    s_add_u32 s30, s38, s39
    buffer_load_dwordx4 v5, s[24:27], s30 offen lds
    s_add_u32 s38, s6, 16
    s_lshl_b32 s38, s38, 10
    s_add_u32 s30, s38, 0
    s_mov_b32 m0, s30
    s_add_u32 s30, s38, s39
    buffer_load_dwordx4 v5, s[24:27], s30 offen lds
    s_and_b32 s38, s6, 3
    s_add_u32 s38, s38, 24
    s_lshl_b32 s38, s38, 10
    s_add_u32 s30, s38, 0
    s_mov_b32 m0, s30
    s_add_u32 s30, s38, s39
    buffer_load_dwordx4 v5, s[24:27], s30 offen lds
    s_lshr_b32 s30, s7, 5
    s_mul_i32 s30, s30, 28672
    s_add_u32 s30, s30, 14680064
    buffer_load_dwordx4 v[16:19], v5, s[24:27], s30 offen offset:0
    buffer_load_dwordx4 v[20:23], v5, s[24:27], s30 offen offset:1024
    buffer_load_dwordx4 v[24:27], v5, s[24:27], s30 offen offset:2048
    buffer_load_dwordx4 v[28:31], v5, s[24:27], s30 offen offset:3072
    s_add_u32 s30, s30, 4096
    buffer_load_dwordx4 v[32:35], v5, s[24:27], s30 offen offset:0
    buffer_load_dwordx4 v[36:39], v5, s[24:27], s30 offen offset:1024
    buffer_load_dwordx4 v[40:43], v5, s[24:27], s30 offen offset:2048
    buffer_load_dwordx4 v[44:47], v5, s[24:27], s30 offen offset:3072
    s_add_u32 s30, s30, 4096
    buffer_load_dwordx4 v[48:51], v5, s[24:27], s30 offen offset:0
    buffer_load_dwordx4 v[52:55], v5, s[24:27], s30 offen offset:1024
    buffer_load_dwordx4 v[56:59], v5, s[24:27], s30 offen offset:2048
    buffer_load_dwordx4 v[60:63], v5, s[24:27], s30 offen offset:3072
    s_add_u32 s30, s30, 4096
    buffer_load_dwordx4 v[64:67], v5, s[24:27], s30 offen offset:0
    buffer_load_dwordx4 v[68:71], v5, s[24:27], s30 offen offset:1024
    buffer_load_dwordx4 v[72:75], v5, s[24:27], s30 offen offset:2048
    buffer_load_dwordx4 v[76:79], v5, s[24:27], s30 offen offset:3072
    s_add_u32 s30, s30, 4096
    buffer_load_dwordx4 v[80:83], v5, s[24:27], s30 offen offset:0
    buffer_load_dwordx4 v[84:87], v5, s[24:27], s30 offen offset:1024
    buffer_load_dwordx4 v[88:91], v5, s[24:27], s30 offen offset:2048
    buffer_load_dwordx4 v[92:95], v5, s[24:27], s30 offen offset:3072
    s_add_u32 s30, s30, 4096
    buffer_load_dwordx4 v[96:99], v5, s[24:27], s30 offen offset:0
    buffer_load_dwordx4 v[100:103], v5, s[24:27], s30 offen offset:1024
    buffer_load_dwordx4 v[104:107], v5, s[24:27], s30 offen offset:2048
    buffer_load_dwordx4 v[108:111], v5, s[24:27], s30 offen offset:3072
    s_add_u32 s30, s30, 4096
    buffer_load_dwordx4 v[112:115], v5, s[24:27], s30 offen offset:0
    buffer_load_dwordx4 v[116:119], v5, s[24:27], s30 offen offset:1024
    buffer_load_dwordx4 v[120:123], v5, s[24:27], s30 offen offset:2048
    buffer_load_dwordx4 v[124:127], v5, s[24:27], s30 offen offset:3072
    s_add_u32 s30, s30, 4096
    s_waitcnt vmcnt(28)
    s_waitcnt lgkmcnt(0)
    s_barrier
    s_mul_i32 s39, s5, 229376
    s_add_u32 s39, s39, 16863232
    s_add_u32 s38, s6, 0
    s_lshl_b32 s38, s38, 10
    s_add_u32 s30, s38, 28672
    s_mov_b32 m0, s30
    s_add_u32 s30, s38, s39
    buffer_load_dwordx4 v5, s[24:27], s30 offen lds
    s_add_u32 s38, s6, 8
    s_lshl_b32 s38, s38, 10
    s_add_u32 s30, s38, 28672
    s_mov_b32 m0, s30
    s_add_u32 s30, s38, s39
    buffer_load_dwordx4 v5, s[24:27], s30 offen lds
    s_add_u32 s38, s6, 16
    s_lshl_b32 s38, s38, 10
    s_add_u32 s30, s38, 28672
    s_mov_b32 m0, s30
    s_add_u32 s30, s38, s39
    buffer_load_dwordx4 v5, s[24:27], s30 offen lds
    s_and_b32 s38, s6, 3
    s_add_u32 s38, s38, 24
    s_lshl_b32 s38, s38, 10
    s_add_u32 s30, s38, 28672
    s_mov_b32 m0, s30
    s_add_u32 s30, s38, s39
    buffer_load_dwordx4 v5, s[24:27], s30 offen lds
    v_mov_b32 v128, 0
    v_mov_b32 v129, 0
    v_mov_b32 v130, 0
    v_mov_b32 v131, 0
    v_mov_b32 v132, 0
    v_mov_b32 v133, 0
    v_mov_b32 v134, 0
    v_mov_b32 v135, 0
    v_mov_b32 v136, 0
    v_mov_b32 v137, 0
    v_mov_b32 v138, 0
    v_mov_b32 v139, 0
    v_mov_b32 v140, 0
    v_mov_b32 v141, 0
    v_mov_b32 v142, 0
    v_mov_b32 v143, 0
    v_add_u32 v2, 0, v6
    ds_read_b64_tr_b16 v[192:193], v2 offset:0
    ds_read_b64_tr_b16 v[194:195], v2 offset:256
    ds_read_b64_tr_b16 v[196:197], v2 offset:1024
    ds_read_b64_tr_b16 v[198:199], v2 offset:1280
    ds_read_b64_tr_b16 v[200:201], v2 offset:2048
    ds_read_b64_tr_b16 v[202:203], v2 offset:2304
    ds_read_b64_tr_b16 v[204:205], v2 offset:3072
    ds_read_b64_tr_b16 v[206:207], v2 offset:3328
    ds_read_b64_tr_b16 v[208:209], v2 offset:4096
    ds_read_b64_tr_b16 v[210:211], v2 offset:4352
    s_waitcnt vmcnt(31)
    s_waitcnt lgkmcnt(8)
    v_mfma_f32_32x32x16_bf16 v[128:143], v[192:195], v[16:19], v[128:143]
    ds_read_b64_tr_b16 v[212:213], v2 offset:5120
    ds_read_b64_tr_b16 v[214:215], v2 offset:5376
    s_waitcnt vmcnt(30)
    s_waitcnt lgkmcnt(8)
    v_mfma_f32_32x32x16_bf16 v[128:143], v[196:199], v[20:23], v[128:143]
    ds_read_b64_tr_b16 v[192:193], v2 offset:6144
    ds_read_b64_tr_b16 v[194:195], v2 offset:6400
    s_waitcnt vmcnt(29)
    s_waitcnt lgkmcnt(8)
    v_mfma_f32_32x32x16_bf16 v[128:143], v[200:203], v[24:27], v[128:143]
    ds_read_b64_tr_b16 v[196:197], v2 offset:7168
    ds_read_b64_tr_b16 v[198:199], v2 offset:7424
    s_waitcnt vmcnt(28)
    s_waitcnt lgkmcnt(8)
    v_mfma_f32_32x32x16_bf16 v[128:143], v[204:207], v[28:31], v[128:143]
    ds_read_b64_tr_b16 v[200:201], v2 offset:8192
    ds_read_b64_tr_b16 v[202:203], v2 offset:8448
    s_waitcnt vmcnt(27)
    s_waitcnt lgkmcnt(8)
    v_mfma_f32_32x32x16_bf16 v[128:143], v[208:211], v[32:35], v[128:143]
    ds_read_b64_tr_b16 v[204:205], v2 offset:9216
    ds_read_b64_tr_b16 v[206:207], v2 offset:9472
    s_waitcnt vmcnt(26)
    s_waitcnt lgkmcnt(8)
    v_mfma_f32_32x32x16_bf16 v[128:143], v[212:215], v[36:39], v[128:143]
    ds_read_b64_tr_b16 v[208:209], v2 offset:10240
    ds_read_b64_tr_b16 v[210:211], v2 offset:10496
    s_waitcnt vmcnt(25)
    s_waitcnt lgkmcnt(8)
    v_mfma_f32_32x32x16_bf16 v[128:143], v[192:195], v[40:43], v[128:143]
    ds_read_b64_tr_b16 v[212:213], v2 offset:11264
    ds_read_b64_tr_b16 v[214:215], v2 offset:11520
    s_waitcnt vmcnt(24)
    s_waitcnt lgkmcnt(8)
    v_mfma_f32_32x32x16_bf16 v[128:143], v[196:199], v[44:47], v[128:143]
    ds_read_b64_tr_b16 v[192:193], v2 offset:12288
    ds_read_b64_tr_b16 v[194:195], v2 offset:12544
    s_waitcnt vmcnt(23)
    s_waitcnt lgkmcnt(8)
    v_mfma_f32_32x32x16_bf16 v[128:143], v[200:203], v[48:51], v[128:143]
    ds_read_b64_tr_b16 v[196:197], v2 offset:13312
    ds_read_b64_tr_b16 v[198:199], v2 offset:13568
    s_waitcnt vmcnt(22)
    s_waitcnt lgkmcnt(8)
    v_mfma_f32_32x32x16_bf16 v[128:143], v[204:207], v[52:55], v[128:143]
    ds_read_b64_tr_b16 v[200:201], v2 offset:14336
    ds_read_b64_tr_b16 v[202:203], v2 offset:14592
    s_waitcnt vmcnt(21)
    s_waitcnt lgkmcnt(8)
    v_mfma_f32_32x32x16_bf16 v[128:143], v[208:211], v[56:59], v[128:143]
    ds_read_b64_tr_b16 v[204:205], v2 offset:15360
    ds_read_b64_tr_b16 v[206:207], v2 offset:15616
    s_waitcnt vmcnt(20)
    s_waitcnt lgkmcnt(8)
    v_mfma_f32_32x32x16_bf16 v[128:143], v[212:215], v[60:63], v[128:143]
    ds_read_b64_tr_b16 v[208:209], v2 offset:16384
    ds_read_b64_tr_b16 v[210:211], v2 offset:16640
    s_waitcnt vmcnt(19)
    s_waitcnt lgkmcnt(8)
    v_mfma_f32_32x32x16_bf16 v[128:143], v[192:195], v[64:67], v[128:143]
    ds_read_b64_tr_b16 v[212:213], v2 offset:17408
    ds_read_b64_tr_b16 v[214:215], v2 offset:17664
    s_waitcnt vmcnt(18)
    s_waitcnt lgkmcnt(8)
    v_mfma_f32_32x32x16_bf16 v[128:143], v[196:199], v[68:71], v[128:143]
    ds_read_b64_tr_b16 v[192:193], v2 offset:18432
    ds_read_b64_tr_b16 v[194:195], v2 offset:18688
    s_waitcnt vmcnt(17)
    s_waitcnt lgkmcnt(8)
    v_mfma_f32_32x32x16_bf16 v[128:143], v[200:203], v[72:75], v[128:143]
    ds_read_b64_tr_b16 v[196:197], v2 offset:19456
    ds_read_b64_tr_b16 v[198:199], v2 offset:19712
    s_waitcnt vmcnt(16)
    s_waitcnt lgkmcnt(8)
    v_mfma_f32_32x32x16_bf16 v[128:143], v[204:207], v[76:79], v[128:143]
    ds_read_b64_tr_b16 v[200:201], v2 offset:20480
    ds_read_b64_tr_b16 v[202:203], v2 offset:20736
    s_waitcnt vmcnt(15)
    s_waitcnt lgkmcnt(8)
    v_mfma_f32_32x32x16_bf16 v[128:143], v[208:211], v[80:83], v[128:143]
    ds_read_b64_tr_b16 v[204:205], v2 offset:21504
    ds_read_b64_tr_b16 v[206:207], v2 offset:21760
    s_waitcnt vmcnt(14)
    s_waitcnt lgkmcnt(8)
    v_mfma_f32_32x32x16_bf16 v[128:143], v[212:215], v[84:87], v[128:143]
    ds_read_b64_tr_b16 v[208:209], v2 offset:22528
    ds_read_b64_tr_b16 v[210:211], v2 offset:22784
    s_waitcnt vmcnt(13)
    s_waitcnt lgkmcnt(8)
    v_mfma_f32_32x32x16_bf16 v[128:143], v[192:195], v[88:91], v[128:143]
    ds_read_b64_tr_b16 v[212:213], v2 offset:23552
    ds_read_b64_tr_b16 v[214:215], v2 offset:23808
    s_waitcnt vmcnt(12)
    s_waitcnt lgkmcnt(8)
    v_mfma_f32_32x32x16_bf16 v[128:143], v[196:199], v[92:95], v[128:143]
    ds_read_b64_tr_b16 v[192:193], v2 offset:24576
    ds_read_b64_tr_b16 v[194:195], v2 offset:24832
    s_waitcnt vmcnt(11)
    s_waitcnt lgkmcnt(8)
    v_mfma_f32_32x32x16_bf16 v[128:143], v[200:203], v[96:99], v[128:143]
    ds_read_b64_tr_b16 v[196:197], v2 offset:25600
    ds_read_b64_tr_b16 v[198:199], v2 offset:25856
    s_waitcnt vmcnt(10)
    s_waitcnt lgkmcnt(8)
    v_mfma_f32_32x32x16_bf16 v[128:143], v[204:207], v[100:103], v[128:143]
    ds_read_b64_tr_b16 v[200:201], v2 offset:26624
    ds_read_b64_tr_b16 v[202:203], v2 offset:26880
    s_waitcnt vmcnt(9)
    s_waitcnt lgkmcnt(8)
    v_mfma_f32_32x32x16_bf16 v[128:143], v[208:211], v[104:107], v[128:143]
    ds_read_b64_tr_b16 v[204:205], v2 offset:27648
    ds_read_b64_tr_b16 v[206:207], v2 offset:27904
    s_waitcnt vmcnt(8)
    s_waitcnt lgkmcnt(8)
    v_mfma_f32_32x32x16_bf16 v[128:143], v[212:215], v[108:111], v[128:143]
    s_waitcnt vmcnt(7)
    s_waitcnt lgkmcnt(6)
    v_mfma_f32_32x32x16_bf16 v[128:143], v[192:195], v[112:115], v[128:143]
    s_waitcnt vmcnt(6)
    s_waitcnt lgkmcnt(4)
    v_mfma_f32_32x32x16_bf16 v[128:143], v[196:199], v[116:119], v[128:143]
    s_waitcnt vmcnt(5)
    s_waitcnt lgkmcnt(2)
    v_mfma_f32_32x32x16_bf16 v[128:143], v[200:203], v[120:123], v[128:143]
    s_waitcnt vmcnt(4)
    s_waitcnt lgkmcnt(0)
    v_mfma_f32_32x32x16_bf16 v[128:143], v[204:207], v[124:127], v[128:143]
    s_waitcnt vmcnt(0)
    s_waitcnt lgkmcnt(0)
    s_barrier
    s_mul_i32 s39, s5, 229376
    s_add_u32 s39, s39, 16891904
    s_add_u32 s38, s6, 0
    s_lshl_b32 s38, s38, 10
    s_add_u32 s30, s38, 0
    s_mov_b32 m0, s30
    s_add_u32 s30, s38, s39
    buffer_load_dwordx4 v5, s[24:27], s30 offen lds
    s_add_u32 s38, s6, 8
    s_lshl_b32 s38, s38, 10
    s_add_u32 s30, s38, 0
    s_mov_b32 m0, s30
    s_add_u32 s30, s38, s39
    buffer_load_dwordx4 v5, s[24:27], s30 offen lds
    s_add_u32 s38, s6, 16
    s_lshl_b32 s38, s38, 10
    s_add_u32 s30, s38, 0
    s_mov_b32 m0, s30
    s_add_u32 s30, s38, s39
    buffer_load_dwordx4 v5, s[24:27], s30 offen lds
    s_and_b32 s38, s6, 3
    s_add_u32 s38, s38, 24
    s_lshl_b32 s38, s38, 10
    s_add_u32 s30, s38, 0
    s_mov_b32 m0, s30
    s_add_u32 s30, s38, s39
    buffer_load_dwordx4 v5, s[24:27], s30 offen lds
    v_mov_b32 v144, 0
    v_mov_b32 v145, 0
    v_mov_b32 v146, 0
    v_mov_b32 v147, 0
    v_mov_b32 v148, 0
    v_mov_b32 v149, 0
    v_mov_b32 v150, 0
    v_mov_b32 v151, 0
    v_mov_b32 v152, 0
    v_mov_b32 v153, 0
    v_mov_b32 v154, 0
    v_mov_b32 v155, 0
    v_mov_b32 v156, 0
    v_mov_b32 v157, 0
    v_mov_b32 v158, 0
    v_mov_b32 v159, 0
    v_add_u32 v2, 28672, v6
    ds_read_b64_tr_b16 v[192:193], v2 offset:0
    ds_read_b64_tr_b16 v[194:195], v2 offset:256
    ds_read_b64_tr_b16 v[196:197], v2 offset:1024
    ds_read_b64_tr_b16 v[198:199], v2 offset:1280
    ds_read_b64_tr_b16 v[200:201], v2 offset:2048
    ds_read_b64_tr_b16 v[202:203], v2 offset:2304
    ds_read_b64_tr_b16 v[204:205], v2 offset:3072
    ds_read_b64_tr_b16 v[206:207], v2 offset:3328
    ds_read_b64_tr_b16 v[208:209], v2 offset:4096
    ds_read_b64_tr_b16 v[210:211], v2 offset:4352
    s_waitcnt lgkmcnt(8)
    v_mfma_f32_32x32x16_bf16 v[144:159], v[192:195], v[16:19], v[144:159]
    ds_read_b64_tr_b16 v[212:213], v2 offset:5120
    ds_read_b64_tr_b16 v[214:215], v2 offset:5376
    s_waitcnt lgkmcnt(8)
    v_mfma_f32_32x32x16_bf16 v[144:159], v[196:199], v[20:23], v[144:159]
    ds_read_b64_tr_b16 v[192:193], v2 offset:6144
    ds_read_b64_tr_b16 v[194:195], v2 offset:6400
    s_waitcnt lgkmcnt(8)
    v_mfma_f32_32x32x16_bf16 v[144:159], v[200:203], v[24:27], v[144:159]
    ds_read_b64_tr_b16 v[196:197], v2 offset:7168
    ds_read_b64_tr_b16 v[198:199], v2 offset:7424
    s_waitcnt lgkmcnt(8)
    v_mfma_f32_32x32x16_bf16 v[144:159], v[204:207], v[28:31], v[144:159]
    ds_read_b64_tr_b16 v[200:201], v2 offset:8192
    ds_read_b64_tr_b16 v[202:203], v2 offset:8448
    s_waitcnt lgkmcnt(8)
    v_mfma_f32_32x32x16_bf16 v[144:159], v[208:211], v[32:35], v[144:159]
    ds_read_b64_tr_b16 v[204:205], v2 offset:9216
    ds_read_b64_tr_b16 v[206:207], v2 offset:9472
    s_waitcnt lgkmcnt(8)
    v_mfma_f32_32x32x16_bf16 v[144:159], v[212:215], v[36:39], v[144:159]
    ds_read_b64_tr_b16 v[208:209], v2 offset:10240
    ds_read_b64_tr_b16 v[210:211], v2 offset:10496
    s_waitcnt lgkmcnt(8)
    v_mfma_f32_32x32x16_bf16 v[144:159], v[192:195], v[40:43], v[144:159]
    ds_read_b64_tr_b16 v[212:213], v2 offset:11264
    ds_read_b64_tr_b16 v[214:215], v2 offset:11520
    s_waitcnt lgkmcnt(8)
    v_mfma_f32_32x32x16_bf16 v[144:159], v[196:199], v[44:47], v[144:159]
    ds_read_b64_tr_b16 v[192:193], v2 offset:12288
    ds_read_b64_tr_b16 v[194:195], v2 offset:12544
    s_waitcnt lgkmcnt(8)
    v_mfma_f32_32x32x16_bf16 v[144:159], v[200:203], v[48:51], v[144:159]
    ds_read_b64_tr_b16 v[196:197], v2 offset:13312
    ds_read_b64_tr_b16 v[198:199], v2 offset:13568
    s_waitcnt lgkmcnt(8)
    v_mfma_f32_32x32x16_bf16 v[144:159], v[204:207], v[52:55], v[144:159]
    ds_read_b64_tr_b16 v[200:201], v2 offset:14336
    ds_read_b64_tr_b16 v[202:203], v2 offset:14592
    s_waitcnt lgkmcnt(8)
    v_mfma_f32_32x32x16_bf16 v[144:159], v[208:211], v[56:59], v[144:159]
    ds_read_b64_tr_b16 v[204:205], v2 offset:15360
    ds_read_b64_tr_b16 v[206:207], v2 offset:15616
    s_waitcnt lgkmcnt(8)
    v_mfma_f32_32x32x16_bf16 v[144:159], v[212:215], v[60:63], v[144:159]
    ds_read_b64_tr_b16 v[208:209], v2 offset:16384
    ds_read_b64_tr_b16 v[210:211], v2 offset:16640
    s_waitcnt lgkmcnt(8)
    v_mfma_f32_32x32x16_bf16 v[144:159], v[192:195], v[64:67], v[144:159]
    ds_read_b64_tr_b16 v[212:213], v2 offset:17408
    ds_read_b64_tr_b16 v[214:215], v2 offset:17664
    s_waitcnt lgkmcnt(8)
    v_mfma_f32_32x32x16_bf16 v[144:159], v[196:199], v[68:71], v[144:159]
    ds_read_b64_tr_b16 v[192:193], v2 offset:18432
    ds_read_b64_tr_b16 v[194:195], v2 offset:18688
    s_waitcnt lgkmcnt(8)
    v_mfma_f32_32x32x16_bf16 v[144:159], v[200:203], v[72:75], v[144:159]
    ds_read_b64_tr_b16 v[196:197], v2 offset:19456
    ds_read_b64_tr_b16 v[198:199], v2 offset:19712
    s_waitcnt lgkmcnt(8)
    v_mfma_f32_32x32x16_bf16 v[144:159], v[204:207], v[76:79], v[144:159]
    ds_read_b64_tr_b16 v[200:201], v2 offset:20480
    ds_read_b64_tr_b16 v[202:203], v2 offset:20736
    s_waitcnt lgkmcnt(8)
    v_mfma_f32_32x32x16_bf16 v[144:159], v[208:211], v[80:83], v[144:159]
    ds_read_b64_tr_b16 v[204:205], v2 offset:21504
    ds_read_b64_tr_b16 v[206:207], v2 offset:21760
    s_waitcnt lgkmcnt(8)
    v_mfma_f32_32x32x16_bf16 v[144:159], v[212:215], v[84:87], v[144:159]
    ds_read_b64_tr_b16 v[208:209], v2 offset:22528
    ds_read_b64_tr_b16 v[210:211], v2 offset:22784
    s_waitcnt lgkmcnt(8)
    v_mfma_f32_32x32x16_bf16 v[144:159], v[192:195], v[88:91], v[144:159]
    ds_read_b64_tr_b16 v[212:213], v2 offset:23552
    ds_read_b64_tr_b16 v[214:215], v2 offset:23808
    s_waitcnt lgkmcnt(8)
    v_mfma_f32_32x32x16_bf16 v[144:159], v[196:199], v[92:95], v[144:159]
    ds_read_b64_tr_b16 v[192:193], v2 offset:24576
    ds_read_b64_tr_b16 v[194:195], v2 offset:24832
    s_waitcnt lgkmcnt(8)
    v_mfma_f32_32x32x16_bf16 v[144:159], v[200:203], v[96:99], v[144:159]
    ds_read_b64_tr_b16 v[196:197], v2 offset:25600
    ds_read_b64_tr_b16 v[198:199], v2 offset:25856
    s_waitcnt lgkmcnt(8)
    v_mfma_f32_32x32x16_bf16 v[144:159], v[204:207], v[100:103], v[144:159]
    ds_read_b64_tr_b16 v[200:201], v2 offset:26624
    ds_read_b64_tr_b16 v[202:203], v2 offset:26880
    s_waitcnt lgkmcnt(8)
    v_mfma_f32_32x32x16_bf16 v[144:159], v[208:211], v[104:107], v[144:159]
    ds_read_b64_tr_b16 v[204:205], v2 offset:27648
    ds_read_b64_tr_b16 v[206:207], v2 offset:27904
    s_waitcnt lgkmcnt(8)
    v_mfma_f32_32x32x16_bf16 v[144:159], v[212:215], v[108:111], v[144:159]
    s_waitcnt lgkmcnt(6)
    v_mfma_f32_32x32x16_bf16 v[144:159], v[192:195], v[112:115], v[144:159]
    s_waitcnt lgkmcnt(4)
    v_mfma_f32_32x32x16_bf16 v[144:159], v[196:199], v[116:119], v[144:159]
    s_waitcnt lgkmcnt(2)
    v_mfma_f32_32x32x16_bf16 v[144:159], v[200:203], v[120:123], v[144:159]
    s_waitcnt lgkmcnt(0)
    v_mfma_f32_32x32x16_bf16 v[144:159], v[204:207], v[124:127], v[144:159]
    s_waitcnt vmcnt(0)
    s_waitcnt lgkmcnt(0)
    s_barrier
    s_mul_i32 s39, s5, 229376
    s_add_u32 s39, s39, 16920576
    s_add_u32 s38, s6, 0
    s_lshl_b32 s38, s38, 10
    s_add_u32 s30, s38, 28672
    s_mov_b32 m0, s30
    s_add_u32 s30, s38, s39
    buffer_load_dwordx4 v5, s[24:27], s30 offen lds
    s_add_u32 s38, s6, 8
    s_lshl_b32 s38, s38, 10
    s_add_u32 s30, s38, 28672
    s_mov_b32 m0, s30
    s_add_u32 s30, s38, s39
    buffer_load_dwordx4 v5, s[24:27], s30 offen lds
    s_add_u32 s38, s6, 16
    s_lshl_b32 s38, s38, 10
    s_add_u32 s30, s38, 28672
    s_mov_b32 m0, s30
    s_add_u32 s30, s38, s39
    buffer_load_dwordx4 v5, s[24:27], s30 offen lds
    s_and_b32 s38, s6, 3
    s_add_u32 s38, s38, 24
    s_lshl_b32 s38, s38, 10
    s_add_u32 s30, s38, 28672
    s_mov_b32 m0, s30
    s_add_u32 s30, s38, s39
    buffer_load_dwordx4 v5, s[24:27], s30 offen lds
    v_mov_b32 v160, 0
    v_mov_b32 v161, 0
    v_mov_b32 v162, 0
    v_mov_b32 v163, 0
    v_mov_b32 v164, 0
    v_mov_b32 v165, 0
    v_mov_b32 v166, 0
    v_mov_b32 v167, 0
    v_mov_b32 v168, 0
    v_mov_b32 v169, 0
    v_mov_b32 v170, 0
    v_mov_b32 v171, 0
    v_mov_b32 v172, 0
    v_mov_b32 v173, 0
    v_mov_b32 v174, 0
    v_mov_b32 v175, 0
    v_add_u32 v2, 0, v6
    ds_read_b64_tr_b16 v[192:193], v2 offset:0
    ds_read_b64_tr_b16 v[194:195], v2 offset:256
    ds_read_b64_tr_b16 v[196:197], v2 offset:1024
    ds_read_b64_tr_b16 v[198:199], v2 offset:1280
    ds_read_b64_tr_b16 v[200:201], v2 offset:2048
    ds_read_b64_tr_b16 v[202:203], v2 offset:2304
    ds_read_b64_tr_b16 v[204:205], v2 offset:3072
    ds_read_b64_tr_b16 v[206:207], v2 offset:3328
    ds_read_b64_tr_b16 v[208:209], v2 offset:4096
    ds_read_b64_tr_b16 v[210:211], v2 offset:4352
    s_waitcnt lgkmcnt(8)
    v_mfma_f32_32x32x16_bf16 v[160:175], v[192:195], v[16:19], v[160:175]
    ds_read_b64_tr_b16 v[212:213], v2 offset:5120
    ds_read_b64_tr_b16 v[214:215], v2 offset:5376
    s_waitcnt lgkmcnt(8)
    v_mfma_f32_32x32x16_bf16 v[160:175], v[196:199], v[20:23], v[160:175]
    v_cvt_pk_bf16_f32 v216, v128, v129
    v_lshlrev_b32 v128, 16, v216
    v_and_b32 v129, 0xffff0000, v216
    v_cvt_pk_bf16_f32 v216, v144, v145
    ds_read_b64_tr_b16 v[192:193], v2 offset:6144
    ds_read_b64_tr_b16 v[194:195], v2 offset:6400
    s_waitcnt lgkmcnt(8)
    v_mfma_f32_32x32x16_bf16 v[160:175], v[200:203], v[24:27], v[160:175]
    v_lshlrev_b32 v144, 16, v216
    v_and_b32 v145, 0xffff0000, v216
    v_mul_f32 v216, s92, v128
    v_exp_f32 v216, v216
    ds_read_b64_tr_b16 v[196:197], v2 offset:7168
    ds_read_b64_tr_b16 v[198:199], v2 offset:7424
    s_waitcnt lgkmcnt(8)
    v_mfma_f32_32x32x16_bf16 v[160:175], v[204:207], v[28:31], v[160:175]
    s_nop 0
    v_add_f32 v216, 1.0, v216
    v_rcp_f32 v216, v216
    s_nop 0
    ds_read_b64_tr_b16 v[200:201], v2 offset:8192
    ds_read_b64_tr_b16 v[202:203], v2 offset:8448
    s_waitcnt lgkmcnt(8)
    v_mfma_f32_32x32x16_bf16 v[160:175], v[208:211], v[32:35], v[160:175]
    v_mul_f32 v128, v128, v216
    v_mul_f32 v217, s92, v129
    v_exp_f32 v217, v217
    s_nop 0
    ds_read_b64_tr_b16 v[204:205], v2 offset:9216
    ds_read_b64_tr_b16 v[206:207], v2 offset:9472
    s_waitcnt lgkmcnt(8)
    v_mfma_f32_32x32x16_bf16 v[160:175], v[212:215], v[36:39], v[160:175]
    v_add_f32 v217, 1.0, v217
    v_rcp_f32 v217, v217
    s_nop 0
    v_mul_f32 v129, v129, v217
    ds_read_b64_tr_b16 v[208:209], v2 offset:10240
    ds_read_b64_tr_b16 v[210:211], v2 offset:10496
    s_waitcnt lgkmcnt(8)
    v_mfma_f32_32x32x16_bf16 v[160:175], v[192:195], v[40:43], v[160:175]
    v_cvt_pk_bf16_f32 v216, v128, v129
    v_lshlrev_b32 v128, 16, v216
    v_and_b32 v129, 0xffff0000, v216
    v_mul_f32 v128, v128, v144
    ds_read_b64_tr_b16 v[212:213], v2 offset:11264
    ds_read_b64_tr_b16 v[214:215], v2 offset:11520
    s_waitcnt lgkmcnt(8)
    v_mfma_f32_32x32x16_bf16 v[160:175], v[196:199], v[44:47], v[160:175]
    v_mul_f32 v129, v129, v145
    v_cvt_pk_bf16_f32 v224, v128, v129
    v_cvt_pk_bf16_f32 v216, v130, v131
    v_lshlrev_b32 v130, 16, v216
    ds_read_b64_tr_b16 v[192:193], v2 offset:12288
    ds_read_b64_tr_b16 v[194:195], v2 offset:12544
    s_waitcnt lgkmcnt(8)
    v_mfma_f32_32x32x16_bf16 v[160:175], v[200:203], v[48:51], v[160:175]
    v_and_b32 v131, 0xffff0000, v216
    v_cvt_pk_bf16_f32 v216, v146, v147
    v_lshlrev_b32 v146, 16, v216
    v_and_b32 v147, 0xffff0000, v216
    ds_read_b64_tr_b16 v[196:197], v2 offset:13312
    ds_read_b64_tr_b16 v[198:199], v2 offset:13568
    s_waitcnt lgkmcnt(8)
    v_mfma_f32_32x32x16_bf16 v[160:175], v[204:207], v[52:55], v[160:175]
    v_mul_f32 v216, s92, v130
    v_exp_f32 v216, v216
    s_nop 0
    v_add_f32 v216, 1.0, v216
    ds_read_b64_tr_b16 v[200:201], v2 offset:14336
    ds_read_b64_tr_b16 v[202:203], v2 offset:14592
    s_waitcnt lgkmcnt(8)
    v_mfma_f32_32x32x16_bf16 v[160:175], v[208:211], v[56:59], v[160:175]
    v_rcp_f32 v216, v216
    s_nop 0
    v_mul_f32 v130, v130, v216
    v_mul_f32 v217, s92, v131
    ds_read_b64_tr_b16 v[204:205], v2 offset:15360
    ds_read_b64_tr_b16 v[206:207], v2 offset:15616
    s_waitcnt lgkmcnt(8)
    v_mfma_f32_32x32x16_bf16 v[160:175], v[212:215], v[60:63], v[160:175]
    v_exp_f32 v217, v217
    s_nop 0
    v_add_f32 v217, 1.0, v217
    v_rcp_f32 v217, v217
    ds_read_b64_tr_b16 v[208:209], v2 offset:16384
    ds_read_b64_tr_b16 v[210:211], v2 offset:16640
    s_waitcnt lgkmcnt(8)
    v_mfma_f32_32x32x16_bf16 v[160:175], v[192:195], v[64:67], v[160:175]
    s_nop 0
    v_mul_f32 v131, v131, v217
    v_cvt_pk_bf16_f32 v216, v130, v131
    v_lshlrev_b32 v130, 16, v216
    ds_read_b64_tr_b16 v[212:213], v2 offset:17408
    ds_read_b64_tr_b16 v[214:215], v2 offset:17664
    s_waitcnt lgkmcnt(8)
    v_mfma_f32_32x32x16_bf16 v[160:175], v[196:199], v[68:71], v[160:175]
    v_and_b32 v131, 0xffff0000, v216
    v_mul_f32 v130, v130, v146
    v_mul_f32 v131, v131, v147
    v_cvt_pk_bf16_f32 v225, v130, v131
    ds_read_b64_tr_b16 v[192:193], v2 offset:18432
    ds_read_b64_tr_b16 v[194:195], v2 offset:18688
    s_waitcnt lgkmcnt(8)
    v_mfma_f32_32x32x16_bf16 v[160:175], v[200:203], v[72:75], v[160:175]
    v_cvt_pk_bf16_f32 v216, v132, v133
    v_lshlrev_b32 v132, 16, v216
    v_and_b32 v133, 0xffff0000, v216
    v_cvt_pk_bf16_f32 v216, v148, v149
    ds_read_b64_tr_b16 v[196:197], v2 offset:19456
    ds_read_b64_tr_b16 v[198:199], v2 offset:19712
    s_waitcnt lgkmcnt(8)
    v_mfma_f32_32x32x16_bf16 v[160:175], v[204:207], v[76:79], v[160:175]
    v_lshlrev_b32 v148, 16, v216
    v_and_b32 v149, 0xffff0000, v216
    v_mul_f32 v216, s92, v132
    v_exp_f32 v216, v216
    ds_read_b64_tr_b16 v[200:201], v2 offset:20480
    ds_read_b64_tr_b16 v[202:203], v2 offset:20736
    s_waitcnt lgkmcnt(8)
    v_mfma_f32_32x32x16_bf16 v[160:175], v[208:211], v[80:83], v[160:175]
    s_nop 0
    v_add_f32 v216, 1.0, v216
    v_rcp_f32 v216, v216
    s_nop 0
    ds_read_b64_tr_b16 v[204:205], v2 offset:21504
    ds_read_b64_tr_b16 v[206:207], v2 offset:21760
    s_waitcnt lgkmcnt(8)
    v_mfma_f32_32x32x16_bf16 v[160:175], v[212:215], v[84:87], v[160:175]
    v_mul_f32 v132, v132, v216
    v_mul_f32 v217, s92, v133
    v_exp_f32 v217, v217
    s_nop 0
    ds_read_b64_tr_b16 v[208:209], v2 offset:22528
    ds_read_b64_tr_b16 v[210:211], v2 offset:22784
    s_waitcnt lgkmcnt(8)
    v_mfma_f32_32x32x16_bf16 v[160:175], v[192:195], v[88:91], v[160:175]
    v_add_f32 v217, 1.0, v217
    v_rcp_f32 v217, v217
    s_nop 0
    v_mul_f32 v133, v133, v217
    ds_read_b64_tr_b16 v[212:213], v2 offset:23552
    ds_read_b64_tr_b16 v[214:215], v2 offset:23808
    s_waitcnt lgkmcnt(8)
    v_mfma_f32_32x32x16_bf16 v[160:175], v[196:199], v[92:95], v[160:175]
    v_cvt_pk_bf16_f32 v216, v132, v133
    v_lshlrev_b32 v132, 16, v216
    v_and_b32 v133, 0xffff0000, v216
    v_mul_f32 v132, v132, v148
    ds_read_b64_tr_b16 v[192:193], v2 offset:24576
    ds_read_b64_tr_b16 v[194:195], v2 offset:24832
    s_waitcnt lgkmcnt(8)
    v_mfma_f32_32x32x16_bf16 v[160:175], v[200:203], v[96:99], v[160:175]
    v_mul_f32 v133, v133, v149
    v_cvt_pk_bf16_f32 v226, v132, v133
    v_cvt_pk_bf16_f32 v216, v134, v135
    v_lshlrev_b32 v134, 16, v216
    ds_read_b64_tr_b16 v[196:197], v2 offset:25600
    ds_read_b64_tr_b16 v[198:199], v2 offset:25856
    s_waitcnt lgkmcnt(8)
    v_mfma_f32_32x32x16_bf16 v[160:175], v[204:207], v[100:103], v[160:175]
    v_and_b32 v135, 0xffff0000, v216
    v_cvt_pk_bf16_f32 v216, v150, v151
    v_lshlrev_b32 v150, 16, v216
    v_and_b32 v151, 0xffff0000, v216
    ds_read_b64_tr_b16 v[200:201], v2 offset:26624
    ds_read_b64_tr_b16 v[202:203], v2 offset:26880
    s_waitcnt lgkmcnt(8)
    v_mfma_f32_32x32x16_bf16 v[160:175], v[208:211], v[104:107], v[160:175]
    v_mul_f32 v216, s92, v134
    v_exp_f32 v216, v216
    s_nop 0
    v_add_f32 v216, 1.0, v216
    ds_read_b64_tr_b16 v[204:205], v2 offset:27648
    ds_read_b64_tr_b16 v[206:207], v2 offset:27904
    s_waitcnt lgkmcnt(8)
    v_mfma_f32_32x32x16_bf16 v[160:175], v[212:215], v[108:111], v[160:175]
    v_rcp_f32 v216, v216
    s_nop 0
    v_mul_f32 v134, v134, v216
    v_mul_f32 v217, s92, v135
    s_waitcnt lgkmcnt(6)
    v_mfma_f32_32x32x16_bf16 v[160:175], v[192:195], v[112:115], v[160:175]
    v_exp_f32 v217, v217
    s_nop 0
    v_add_f32 v217, 1.0, v217
    v_rcp_f32 v217, v217
    s_waitcnt lgkmcnt(4)
    v_mfma_f32_32x32x16_bf16 v[160:175], v[196:199], v[116:119], v[160:175]
    s_nop 0
    v_mul_f32 v135, v135, v217
    v_cvt_pk_bf16_f32 v216, v134, v135
    v_lshlrev_b32 v134, 16, v216
    s_waitcnt lgkmcnt(2)
    v_mfma_f32_32x32x16_bf16 v[160:175], v[200:203], v[120:123], v[160:175]
    v_and_b32 v135, 0xffff0000, v216
    v_mul_f32 v134, v134, v150
    v_mul_f32 v135, v135, v151
    v_cvt_pk_bf16_f32 v227, v134, v135
    s_waitcnt lgkmcnt(0)
    v_mfma_f32_32x32x16_bf16 v[160:175], v[204:207], v[124:127], v[160:175]
    v_cvt_pk_bf16_f32 v216, v136, v137
    v_lshlrev_b32 v136, 16, v216
    v_and_b32 v137, 0xffff0000, v216
    v_cvt_pk_bf16_f32 v216, v152, v153
    s_waitcnt vmcnt(0)
    s_waitcnt lgkmcnt(0)
    s_barrier
    s_mul_i32 s39, s5, 229376
    s_add_u32 s39, s39, 16949248
    s_add_u32 s38, s6, 0
    s_lshl_b32 s38, s38, 10
    s_add_u32 s30, s38, 0
    s_mov_b32 m0, s30
    s_add_u32 s30, s38, s39
    buffer_load_dwordx4 v5, s[24:27], s30 offen lds
    s_add_u32 s38, s6, 8
    s_lshl_b32 s38, s38, 10
    s_add_u32 s30, s38, 0
    s_mov_b32 m0, s30
    s_add_u32 s30, s38, s39
    buffer_load_dwordx4 v5, s[24:27], s30 offen lds
    s_add_u32 s38, s6, 16
    s_lshl_b32 s38, s38, 10
    s_add_u32 s30, s38, 0
    s_mov_b32 m0, s30
    s_add_u32 s30, s38, s39
    buffer_load_dwordx4 v5, s[24:27], s30 offen lds
    s_and_b32 s38, s6, 3
    s_add_u32 s38, s38, 24
    s_lshl_b32 s38, s38, 10
    s_add_u32 s30, s38, 0
    s_mov_b32 m0, s30
    s_add_u32 s30, s38, s39
    buffer_load_dwordx4 v5, s[24:27], s30 offen lds
    v_mov_b32 v176, 0
    v_mov_b32 v177, 0
    v_mov_b32 v178, 0
    v_mov_b32 v179, 0
    v_mov_b32 v180, 0
    v_mov_b32 v181, 0
    v_mov_b32 v182, 0
    v_mov_b32 v183, 0
    v_mov_b32 v184, 0
    v_mov_b32 v185, 0
    v_mov_b32 v186, 0
    v_mov_b32 v187, 0
    v_mov_b32 v188, 0
    v_mov_b32 v189, 0
    v_mov_b32 v190, 0
    v_mov_b32 v191, 0
    v_add_u32 v2, 28672, v6
    ds_read_b64_tr_b16 v[192:193], v2 offset:0
    ds_read_b64_tr_b16 v[194:195], v2 offset:256
    ds_read_b64_tr_b16 v[196:197], v2 offset:1024
    ds_read_b64_tr_b16 v[198:199], v2 offset:1280
    ds_read_b64_tr_b16 v[200:201], v2 offset:2048
    ds_read_b64_tr_b16 v[202:203], v2 offset:2304
    ds_read_b64_tr_b16 v[204:205], v2 offset:3072
    ds_read_b64_tr_b16 v[206:207], v2 offset:3328
    ds_read_b64_tr_b16 v[208:209], v2 offset:4096
    ds_read_b64_tr_b16 v[210:211], v2 offset:4352
    s_waitcnt lgkmcnt(8)
    v_mfma_f32_32x32x16_bf16 v[176:191], v[192:195], v[16:19], v[176:191]
    ds_read_b64_tr_b16 v[212:213], v2 offset:5120
    ds_read_b64_tr_b16 v[214:215], v2 offset:5376
    s_waitcnt lgkmcnt(8)
    v_mfma_f32_32x32x16_bf16 v[176:191], v[196:199], v[20:23], v[176:191]
    v_lshlrev_b32 v152, 16, v216
    v_and_b32 v153, 0xffff0000, v216
    v_mul_f32 v216, s92, v136
    v_exp_f32 v216, v216
    ds_read_b64_tr_b16 v[192:193], v2 offset:6144
    ds_read_b64_tr_b16 v[194:195], v2 offset:6400
    s_waitcnt lgkmcnt(8)
    v_mfma_f32_32x32x16_bf16 v[176:191], v[200:203], v[24:27], v[176:191]
    s_nop 0
    v_add_f32 v216, 1.0, v216
    v_rcp_f32 v216, v216
    s_nop 0
    ds_read_b64_tr_b16 v[196:197], v2 offset:7168
    ds_read_b64_tr_b16 v[198:199], v2 offset:7424
    s_waitcnt lgkmcnt(8)
    v_mfma_f32_32x32x16_bf16 v[176:191], v[204:207], v[28:31], v[176:191]
    v_mul_f32 v136, v136, v216
    v_mul_f32 v217, s92, v137
    v_exp_f32 v217, v217
    s_nop 0
    ds_read_b64_tr_b16 v[200:201], v2 offset:8192
    ds_read_b64_tr_b16 v[202:203], v2 offset:8448
    s_waitcnt lgkmcnt(8)
    v_mfma_f32_32x32x16_bf16 v[176:191], v[208:211], v[32:35], v[176:191]
    v_add_f32 v217, 1.0, v217
    v_rcp_f32 v217, v217
    s_nop 0
    v_mul_f32 v137, v137, v217
    ds_read_b64_tr_b16 v[204:205], v2 offset:9216
    ds_read_b64_tr_b16 v[206:207], v2 offset:9472
    s_waitcnt lgkmcnt(8)
    v_mfma_f32_32x32x16_bf16 v[176:191], v[212:215], v[36:39], v[176:191]
    v_cvt_pk_bf16_f32 v216, v136, v137
    v_lshlrev_b32 v136, 16, v216
    v_and_b32 v137, 0xffff0000, v216
    v_mul_f32 v136, v136, v152
    ds_read_b64_tr_b16 v[208:209], v2 offset:10240
    ds_read_b64_tr_b16 v[210:211], v2 offset:10496
    s_waitcnt lgkmcnt(8)
    v_mfma_f32_32x32x16_bf16 v[176:191], v[192:195], v[40:43], v[176:191]
    v_mul_f32 v137, v137, v153
    v_cvt_pk_bf16_f32 v228, v136, v137
    v_cvt_pk_bf16_f32 v216, v138, v139
    v_lshlrev_b32 v138, 16, v216
    ds_read_b64_tr_b16 v[212:213], v2 offset:11264
    ds_read_b64_tr_b16 v[214:215], v2 offset:11520
    s_waitcnt lgkmcnt(8)
    v_mfma_f32_32x32x16_bf16 v[176:191], v[196:199], v[44:47], v[176:191]
    v_and_b32 v139, 0xffff0000, v216
    v_cvt_pk_bf16_f32 v216, v154, v155
    v_lshlrev_b32 v154, 16, v216
    v_and_b32 v155, 0xffff0000, v216
    ds_read_b64_tr_b16 v[192:193], v2 offset:12288
    ds_read_b64_tr_b16 v[194:195], v2 offset:12544
    s_waitcnt lgkmcnt(8)
    v_mfma_f32_32x32x16_bf16 v[176:191], v[200:203], v[48:51], v[176:191]
    v_mul_f32 v216, s92, v138
    v_exp_f32 v216, v216
    s_nop 0
    v_add_f32 v216, 1.0, v216
    ds_read_b64_tr_b16 v[196:197], v2 offset:13312
    ds_read_b64_tr_b16 v[198:199], v2 offset:13568
    s_waitcnt lgkmcnt(8)
    v_mfma_f32_32x32x16_bf16 v[176:191], v[204:207], v[52:55], v[176:191]
    v_rcp_f32 v216, v216
    s_nop 0
    v_mul_f32 v138, v138, v216
    v_mul_f32 v217, s92, v139
    ds_read_b64_tr_b16 v[200:201], v2 offset:14336
    ds_read_b64_tr_b16 v[202:203], v2 offset:14592
    s_waitcnt lgkmcnt(8)
    v_mfma_f32_32x32x16_bf16 v[176:191], v[208:211], v[56:59], v[176:191]
    v_exp_f32 v217, v217
    s_nop 0
    v_add_f32 v217, 1.0, v217
    v_rcp_f32 v217, v217
    ds_read_b64_tr_b16 v[204:205], v2 offset:15360
    ds_read_b64_tr_b16 v[206:207], v2 offset:15616
    s_waitcnt lgkmcnt(8)
    v_mfma_f32_32x32x16_bf16 v[176:191], v[212:215], v[60:63], v[176:191]
    s_nop 0
    v_mul_f32 v139, v139, v217
    v_cvt_pk_bf16_f32 v216, v138, v139
    v_lshlrev_b32 v138, 16, v216
    ds_read_b64_tr_b16 v[208:209], v2 offset:16384
    ds_read_b64_tr_b16 v[210:211], v2 offset:16640
    s_waitcnt lgkmcnt(8)
    v_mfma_f32_32x32x16_bf16 v[176:191], v[192:195], v[64:67], v[176:191]
    v_and_b32 v139, 0xffff0000, v216
    v_mul_f32 v138, v138, v154
    v_mul_f32 v139, v139, v155
    v_cvt_pk_bf16_f32 v229, v138, v139
    ds_read_b64_tr_b16 v[212:213], v2 offset:17408
    ds_read_b64_tr_b16 v[214:215], v2 offset:17664
    s_waitcnt lgkmcnt(8)
    v_mfma_f32_32x32x16_bf16 v[176:191], v[196:199], v[68:71], v[176:191]
    v_cvt_pk_bf16_f32 v216, v140, v141
    v_lshlrev_b32 v140, 16, v216
    v_and_b32 v141, 0xffff0000, v216
    v_cvt_pk_bf16_f32 v216, v156, v157
    ds_read_b64_tr_b16 v[192:193], v2 offset:18432
    ds_read_b64_tr_b16 v[194:195], v2 offset:18688
    s_waitcnt lgkmcnt(8)
    v_mfma_f32_32x32x16_bf16 v[176:191], v[200:203], v[72:75], v[176:191]
    v_lshlrev_b32 v156, 16, v216
    v_and_b32 v157, 0xffff0000, v216
    v_mul_f32 v216, s92, v140
    v_exp_f32 v216, v216
    ds_read_b64_tr_b16 v[196:197], v2 offset:19456
    ds_read_b64_tr_b16 v[198:199], v2 offset:19712
    s_waitcnt lgkmcnt(8)
    v_mfma_f32_32x32x16_bf16 v[176:191], v[204:207], v[76:79], v[176:191]
    s_nop 0
    v_add_f32 v216, 1.0, v216
    v_rcp_f32 v216, v216
    s_nop 0
    ds_read_b64_tr_b16 v[200:201], v2 offset:20480
    ds_read_b64_tr_b16 v[202:203], v2 offset:20736
    s_waitcnt lgkmcnt(8)
    v_mfma_f32_32x32x16_bf16 v[176:191], v[208:211], v[80:83], v[176:191]
    v_mul_f32 v140, v140, v216
    v_mul_f32 v217, s92, v141
    v_exp_f32 v217, v217
    s_nop 0
    ds_read_b64_tr_b16 v[204:205], v2 offset:21504
    ds_read_b64_tr_b16 v[206:207], v2 offset:21760
    s_waitcnt lgkmcnt(8)
    v_mfma_f32_32x32x16_bf16 v[176:191], v[212:215], v[84:87], v[176:191]
    v_add_f32 v217, 1.0, v217
    v_rcp_f32 v217, v217
    s_nop 0
    v_mul_f32 v141, v141, v217
    ds_read_b64_tr_b16 v[208:209], v2 offset:22528
    ds_read_b64_tr_b16 v[210:211], v2 offset:22784
    s_waitcnt lgkmcnt(8)
    v_mfma_f32_32x32x16_bf16 v[176:191], v[192:195], v[88:91], v[176:191]
    v_cvt_pk_bf16_f32 v216, v140, v141
    v_lshlrev_b32 v140, 16, v216
    v_and_b32 v141, 0xffff0000, v216
    v_mul_f32 v140, v140, v156
    ds_read_b64_tr_b16 v[212:213], v2 offset:23552
    ds_read_b64_tr_b16 v[214:215], v2 offset:23808
    s_waitcnt lgkmcnt(8)
    v_mfma_f32_32x32x16_bf16 v[176:191], v[196:199], v[92:95], v[176:191]
    v_mul_f32 v141, v141, v157
    v_cvt_pk_bf16_f32 v230, v140, v141
    v_cvt_pk_bf16_f32 v216, v142, v143
    v_lshlrev_b32 v142, 16, v216
    ds_read_b64_tr_b16 v[192:193], v2 offset:24576
    ds_read_b64_tr_b16 v[194:195], v2 offset:24832
    s_waitcnt lgkmcnt(8)
    v_mfma_f32_32x32x16_bf16 v[176:191], v[200:203], v[96:99], v[176:191]
    v_and_b32 v143, 0xffff0000, v216
    v_cvt_pk_bf16_f32 v216, v158, v159
    v_lshlrev_b32 v158, 16, v216
    v_and_b32 v159, 0xffff0000, v216
    ds_read_b64_tr_b16 v[196:197], v2 offset:25600
    ds_read_b64_tr_b16 v[198:199], v2 offset:25856
    s_waitcnt lgkmcnt(8)
    v_mfma_f32_32x32x16_bf16 v[176:191], v[204:207], v[100:103], v[176:191]
    v_mul_f32 v216, s92, v142
    v_exp_f32 v216, v216
    s_nop 0
    v_add_f32 v216, 1.0, v216
    ds_read_b64_tr_b16 v[200:201], v2 offset:26624
    ds_read_b64_tr_b16 v[202:203], v2 offset:26880
    s_waitcnt lgkmcnt(8)
    v_mfma_f32_32x32x16_bf16 v[176:191], v[208:211], v[104:107], v[176:191]
    v_rcp_f32 v216, v216
    s_nop 0
    v_mul_f32 v142, v142, v216
    v_mul_f32 v217, s92, v143
    ds_read_b64_tr_b16 v[204:205], v2 offset:27648
    ds_read_b64_tr_b16 v[206:207], v2 offset:27904
    s_waitcnt lgkmcnt(8)
    v_mfma_f32_32x32x16_bf16 v[176:191], v[212:215], v[108:111], v[176:191]
    v_exp_f32 v217, v217
    s_nop 0
    v_add_f32 v217, 1.0, v217
    v_rcp_f32 v217, v217
    s_waitcnt lgkmcnt(6)
    v_mfma_f32_32x32x16_bf16 v[176:191], v[192:195], v[112:115], v[176:191]
    s_nop 0
    v_mul_f32 v143, v143, v217
    v_cvt_pk_bf16_f32 v216, v142, v143
    v_lshlrev_b32 v142, 16, v216
    s_waitcnt lgkmcnt(4)
    v_mfma_f32_32x32x16_bf16 v[176:191], v[196:199], v[116:119], v[176:191]
    v_and_b32 v143, 0xffff0000, v216
    v_mul_f32 v142, v142, v158
    v_mul_f32 v143, v143, v159
    v_cvt_pk_bf16_f32 v231, v142, v143
    s_waitcnt lgkmcnt(2)
    v_mfma_f32_32x32x16_bf16 v[176:191], v[200:203], v[120:123], v[176:191]
    s_movk_i32 s39, 2048
    buffer_store_dwordx4 v[224:227], v15, s[24:27], s39 offen
    buffer_store_dwordx4 v[228:231], v15, s[24:27], s39 offen offset:1024
    s_nop 1
    s_waitcnt lgkmcnt(0)
    v_mfma_f32_32x32x16_bf16 v[176:191], v[204:207], v[124:127], v[176:191]
    s_waitcnt vmcnt(2)
    s_waitcnt lgkmcnt(0)
    s_barrier
    s_mul_i32 s39, s5, 229376
    s_add_u32 s39, s39, 16977920
    s_add_u32 s38, s6, 0
    s_lshl_b32 s38, s38, 10
    s_add_u32 s30, s38, 28672
    s_mov_b32 m0, s30
    s_add_u32 s30, s38, s39
    buffer_load_dwordx4 v5, s[24:27], s30 offen lds
    s_add_u32 s38, s6, 8
    s_lshl_b32 s38, s38, 10
    s_add_u32 s30, s38, 28672
    s_mov_b32 m0, s30
    s_add_u32 s30, s38, s39
    buffer_load_dwordx4 v5, s[24:27], s30 offen lds
    s_add_u32 s38, s6, 16
    s_lshl_b32 s38, s38, 10
    s_add_u32 s30, s38, 28672
    s_mov_b32 m0, s30
    s_add_u32 s30, s38, s39
    buffer_load_dwordx4 v5, s[24:27], s30 offen lds
    s_and_b32 s38, s6, 3
    s_add_u32 s38, s38, 24
    s_lshl_b32 s38, s38, 10
    s_add_u32 s30, s38, 28672
    s_mov_b32 m0, s30
    s_add_u32 s30, s38, s39
    buffer_load_dwordx4 v5, s[24:27], s30 offen lds
    v_mov_b32 v128, 0
    v_mov_b32 v129, 0
    v_mov_b32 v130, 0
    v_mov_b32 v131, 0
    v_mov_b32 v132, 0
    v_mov_b32 v133, 0
    v_mov_b32 v134, 0
    v_mov_b32 v135, 0
    v_mov_b32 v136, 0
    v_mov_b32 v137, 0
    v_mov_b32 v138, 0
    v_mov_b32 v139, 0
    v_mov_b32 v140, 0
    v_mov_b32 v141, 0
    v_mov_b32 v142, 0
    v_mov_b32 v143, 0
    v_add_u32 v2, 0, v6
    ds_read_b64_tr_b16 v[192:193], v2 offset:0
    ds_read_b64_tr_b16 v[194:195], v2 offset:256
    ds_read_b64_tr_b16 v[196:197], v2 offset:1024
    ds_read_b64_tr_b16 v[198:199], v2 offset:1280
    ds_read_b64_tr_b16 v[200:201], v2 offset:2048
    ds_read_b64_tr_b16 v[202:203], v2 offset:2304
    ds_read_b64_tr_b16 v[204:205], v2 offset:3072
    ds_read_b64_tr_b16 v[206:207], v2 offset:3328
    ds_read_b64_tr_b16 v[208:209], v2 offset:4096
    ds_read_b64_tr_b16 v[210:211], v2 offset:4352
    s_waitcnt lgkmcnt(8)
    v_mfma_f32_32x32x16_bf16 v[128:143], v[192:195], v[16:19], v[128:143]
    ds_read_b64_tr_b16 v[212:213], v2 offset:5120
    ds_read_b64_tr_b16 v[214:215], v2 offset:5376
    s_waitcnt lgkmcnt(8)
    v_mfma_f32_32x32x16_bf16 v[128:143], v[196:199], v[20:23], v[128:143]
    v_cvt_pk_bf16_f32 v216, v160, v161
    v_lshlrev_b32 v160, 16, v216
    v_and_b32 v161, 0xffff0000, v216
    v_cvt_pk_bf16_f32 v216, v176, v177
    ds_read_b64_tr_b16 v[192:193], v2 offset:6144
    ds_read_b64_tr_b16 v[194:195], v2 offset:6400
    s_waitcnt lgkmcnt(8)
    v_mfma_f32_32x32x16_bf16 v[128:143], v[200:203], v[24:27], v[128:143]
    v_lshlrev_b32 v176, 16, v216
    v_and_b32 v177, 0xffff0000, v216
    v_mul_f32 v216, s92, v160
    v_exp_f32 v216, v216
    ds_read_b64_tr_b16 v[196:197], v2 offset:7168
    ds_read_b64_tr_b16 v[198:199], v2 offset:7424
    s_waitcnt lgkmcnt(8)
    v_mfma_f32_32x32x16_bf16 v[128:143], v[204:207], v[28:31], v[128:143]
    s_nop 0
    v_add_f32 v216, 1.0, v216
    v_rcp_f32 v216, v216
    s_nop 0
    ds_read_b64_tr_b16 v[200:201], v2 offset:8192
    ds_read_b64_tr_b16 v[202:203], v2 offset:8448
    s_waitcnt lgkmcnt(8)
    v_mfma_f32_32x32x16_bf16 v[128:143], v[208:211], v[32:35], v[128:143]
    v_mul_f32 v160, v160, v216
    v_mul_f32 v217, s92, v161
    v_exp_f32 v217, v217
    s_nop 0
    ds_read_b64_tr_b16 v[204:205], v2 offset:9216
    ds_read_b64_tr_b16 v[206:207], v2 offset:9472
    s_waitcnt lgkmcnt(8)
    v_mfma_f32_32x32x16_bf16 v[128:143], v[212:215], v[36:39], v[128:143]
    v_add_f32 v217, 1.0, v217
    v_rcp_f32 v217, v217
    s_nop 0
    v_mul_f32 v161, v161, v217
    ds_read_b64_tr_b16 v[208:209], v2 offset:10240
    ds_read_b64_tr_b16 v[210:211], v2 offset:10496
    s_waitcnt lgkmcnt(8)
    v_mfma_f32_32x32x16_bf16 v[128:143], v[192:195], v[40:43], v[128:143]
    v_cvt_pk_bf16_f32 v216, v160, v161
    v_lshlrev_b32 v160, 16, v216
    v_and_b32 v161, 0xffff0000, v216
    v_mul_f32 v160, v160, v176
    ds_read_b64_tr_b16 v[212:213], v2 offset:11264
    ds_read_b64_tr_b16 v[214:215], v2 offset:11520
    s_waitcnt lgkmcnt(8)
    v_mfma_f32_32x32x16_bf16 v[128:143], v[196:199], v[44:47], v[128:143]
    v_mul_f32 v161, v161, v177
    v_cvt_pk_bf16_f32 v224, v160, v161
    v_cvt_pk_bf16_f32 v216, v162, v163
    v_lshlrev_b32 v162, 16, v216
    ds_read_b64_tr_b16 v[192:193], v2 offset:12288
    ds_read_b64_tr_b16 v[194:195], v2 offset:12544
    s_waitcnt lgkmcnt(8)
    v_mfma_f32_32x32x16_bf16 v[128:143], v[200:203], v[48:51], v[128:143]
    v_and_b32 v163, 0xffff0000, v216
    v_cvt_pk_bf16_f32 v216, v178, v179
    v_lshlrev_b32 v178, 16, v216
    v_and_b32 v179, 0xffff0000, v216
    ds_read_b64_tr_b16 v[196:197], v2 offset:13312
    ds_read_b64_tr_b16 v[198:199], v2 offset:13568
    s_waitcnt lgkmcnt(8)
    v_mfma_f32_32x32x16_bf16 v[128:143], v[204:207], v[52:55], v[128:143]
    v_mul_f32 v216, s92, v162
    v_exp_f32 v216, v216
    s_nop 0
    v_add_f32 v216, 1.0, v216
    ds_read_b64_tr_b16 v[200:201], v2 offset:14336
    ds_read_b64_tr_b16 v[202:203], v2 offset:14592
    s_waitcnt lgkmcnt(8)
    v_mfma_f32_32x32x16_bf16 v[128:143], v[208:211], v[56:59], v[128:143]
    v_rcp_f32 v216, v216
    s_nop 0
    v_mul_f32 v162, v162, v216
    v_mul_f32 v217, s92, v163
    ds_read_b64_tr_b16 v[204:205], v2 offset:15360
    ds_read_b64_tr_b16 v[206:207], v2 offset:15616
    s_waitcnt lgkmcnt(8)
    v_mfma_f32_32x32x16_bf16 v[128:143], v[212:215], v[60:63], v[128:143]
    v_exp_f32 v217, v217
    s_nop 0
    v_add_f32 v217, 1.0, v217
    v_rcp_f32 v217, v217
    ds_read_b64_tr_b16 v[208:209], v2 offset:16384
    ds_read_b64_tr_b16 v[210:211], v2 offset:16640
    s_waitcnt lgkmcnt(8)
    v_mfma_f32_32x32x16_bf16 v[128:143], v[192:195], v[64:67], v[128:143]
    s_nop 0
    v_mul_f32 v163, v163, v217
    v_cvt_pk_bf16_f32 v216, v162, v163
    v_lshlrev_b32 v162, 16, v216
    ds_read_b64_tr_b16 v[212:213], v2 offset:17408
    ds_read_b64_tr_b16 v[214:215], v2 offset:17664
    s_waitcnt lgkmcnt(8)
    v_mfma_f32_32x32x16_bf16 v[128:143], v[196:199], v[68:71], v[128:143]
    v_and_b32 v163, 0xffff0000, v216
    v_mul_f32 v162, v162, v178
    v_mul_f32 v163, v163, v179
    v_cvt_pk_bf16_f32 v225, v162, v163
    ds_read_b64_tr_b16 v[192:193], v2 offset:18432
    ds_read_b64_tr_b16 v[194:195], v2 offset:18688
    s_waitcnt lgkmcnt(8)
    v_mfma_f32_32x32x16_bf16 v[128:143], v[200:203], v[72:75], v[128:143]
    v_cvt_pk_bf16_f32 v216, v164, v165
    v_lshlrev_b32 v164, 16, v216
    v_and_b32 v165, 0xffff0000, v216
    v_cvt_pk_bf16_f32 v216, v180, v181
    ds_read_b64_tr_b16 v[196:197], v2 offset:19456
    ds_read_b64_tr_b16 v[198:199], v2 offset:19712
    s_waitcnt lgkmcnt(8)
    v_mfma_f32_32x32x16_bf16 v[128:143], v[204:207], v[76:79], v[128:143]
    v_lshlrev_b32 v180, 16, v216
    v_and_b32 v181, 0xffff0000, v216
    v_mul_f32 v216, s92, v164
    v_exp_f32 v216, v216
    ds_read_b64_tr_b16 v[200:201], v2 offset:20480
    ds_read_b64_tr_b16 v[202:203], v2 offset:20736
    s_waitcnt lgkmcnt(8)
    v_mfma_f32_32x32x16_bf16 v[128:143], v[208:211], v[80:83], v[128:143]
    s_nop 0
    v_add_f32 v216, 1.0, v216
    v_rcp_f32 v216, v216
    s_nop 0
    ds_read_b64_tr_b16 v[204:205], v2 offset:21504
    ds_read_b64_tr_b16 v[206:207], v2 offset:21760
    s_waitcnt lgkmcnt(8)
    v_mfma_f32_32x32x16_bf16 v[128:143], v[212:215], v[84:87], v[128:143]
    v_mul_f32 v164, v164, v216
    v_mul_f32 v217, s92, v165
    v_exp_f32 v217, v217
    s_nop 0
    ds_read_b64_tr_b16 v[208:209], v2 offset:22528
    ds_read_b64_tr_b16 v[210:211], v2 offset:22784
    s_waitcnt lgkmcnt(8)
    v_mfma_f32_32x32x16_bf16 v[128:143], v[192:195], v[88:91], v[128:143]
    v_add_f32 v217, 1.0, v217
    v_rcp_f32 v217, v217
    s_nop 0
    v_mul_f32 v165, v165, v217
    ds_read_b64_tr_b16 v[212:213], v2 offset:23552
    ds_read_b64_tr_b16 v[214:215], v2 offset:23808
    s_waitcnt lgkmcnt(8)
    v_mfma_f32_32x32x16_bf16 v[128:143], v[196:199], v[92:95], v[128:143]
    v_cvt_pk_bf16_f32 v216, v164, v165
    v_lshlrev_b32 v164, 16, v216
    v_and_b32 v165, 0xffff0000, v216
    v_mul_f32 v164, v164, v180
    ds_read_b64_tr_b16 v[192:193], v2 offset:24576
    ds_read_b64_tr_b16 v[194:195], v2 offset:24832
    s_waitcnt lgkmcnt(8)
    v_mfma_f32_32x32x16_bf16 v[128:143], v[200:203], v[96:99], v[128:143]
    v_mul_f32 v165, v165, v181
    v_cvt_pk_bf16_f32 v226, v164, v165
    v_cvt_pk_bf16_f32 v216, v166, v167
    v_lshlrev_b32 v166, 16, v216
    ds_read_b64_tr_b16 v[196:197], v2 offset:25600
    ds_read_b64_tr_b16 v[198:199], v2 offset:25856
    s_waitcnt lgkmcnt(8)
    v_mfma_f32_32x32x16_bf16 v[128:143], v[204:207], v[100:103], v[128:143]
    v_and_b32 v167, 0xffff0000, v216
    v_cvt_pk_bf16_f32 v216, v182, v183
    v_lshlrev_b32 v182, 16, v216
    v_and_b32 v183, 0xffff0000, v216
    ds_read_b64_tr_b16 v[200:201], v2 offset:26624
    ds_read_b64_tr_b16 v[202:203], v2 offset:26880
    s_waitcnt lgkmcnt(8)
    v_mfma_f32_32x32x16_bf16 v[128:143], v[208:211], v[104:107], v[128:143]
    v_mul_f32 v216, s92, v166
    v_exp_f32 v216, v216
    s_nop 0
    v_add_f32 v216, 1.0, v216
    ds_read_b64_tr_b16 v[204:205], v2 offset:27648
    ds_read_b64_tr_b16 v[206:207], v2 offset:27904
    s_waitcnt lgkmcnt(8)
    v_mfma_f32_32x32x16_bf16 v[128:143], v[212:215], v[108:111], v[128:143]
    v_rcp_f32 v216, v216
    s_nop 0
    v_mul_f32 v166, v166, v216
    v_mul_f32 v217, s92, v167
    s_waitcnt lgkmcnt(6)
    v_mfma_f32_32x32x16_bf16 v[128:143], v[192:195], v[112:115], v[128:143]
    v_exp_f32 v217, v217
    s_nop 0
    v_add_f32 v217, 1.0, v217
    v_rcp_f32 v217, v217
    s_waitcnt lgkmcnt(4)
    v_mfma_f32_32x32x16_bf16 v[128:143], v[196:199], v[116:119], v[128:143]
    s_nop 0
    v_mul_f32 v167, v167, v217
    v_cvt_pk_bf16_f32 v216, v166, v167
    v_lshlrev_b32 v166, 16, v216
    s_waitcnt lgkmcnt(2)
    v_mfma_f32_32x32x16_bf16 v[128:143], v[200:203], v[120:123], v[128:143]
    v_and_b32 v167, 0xffff0000, v216
    v_mul_f32 v166, v166, v182
    v_mul_f32 v167, v167, v183
    v_cvt_pk_bf16_f32 v227, v166, v167
    s_waitcnt lgkmcnt(0)
    v_mfma_f32_32x32x16_bf16 v[128:143], v[204:207], v[124:127], v[128:143]
    v_cvt_pk_bf16_f32 v216, v168, v169
    v_lshlrev_b32 v168, 16, v216
    v_and_b32 v169, 0xffff0000, v216
    v_cvt_pk_bf16_f32 v216, v184, v185
    s_waitcnt vmcnt(0)
    s_waitcnt lgkmcnt(0)
    s_barrier
    v_mov_b32 v144, 0
    v_mov_b32 v145, 0
    v_mov_b32 v146, 0
    v_mov_b32 v147, 0
    v_mov_b32 v148, 0
    v_mov_b32 v149, 0
    v_mov_b32 v150, 0
    v_mov_b32 v151, 0
    v_mov_b32 v152, 0
    v_mov_b32 v153, 0
    v_mov_b32 v154, 0
    v_mov_b32 v155, 0
    v_mov_b32 v156, 0
    v_mov_b32 v157, 0
    v_mov_b32 v158, 0
    v_mov_b32 v159, 0
    v_add_u32 v2, 28672, v6
    ds_read_b64_tr_b16 v[192:193], v2 offset:0
    ds_read_b64_tr_b16 v[194:195], v2 offset:256
    ds_read_b64_tr_b16 v[196:197], v2 offset:1024
    ds_read_b64_tr_b16 v[198:199], v2 offset:1280
    ds_read_b64_tr_b16 v[200:201], v2 offset:2048
    ds_read_b64_tr_b16 v[202:203], v2 offset:2304
    ds_read_b64_tr_b16 v[204:205], v2 offset:3072
    ds_read_b64_tr_b16 v[206:207], v2 offset:3328
    ds_read_b64_tr_b16 v[208:209], v2 offset:4096
    ds_read_b64_tr_b16 v[210:211], v2 offset:4352
    s_waitcnt lgkmcnt(8)
    v_mfma_f32_32x32x16_bf16 v[144:159], v[192:195], v[16:19], v[144:159]
    ds_read_b64_tr_b16 v[212:213], v2 offset:5120
    ds_read_b64_tr_b16 v[214:215], v2 offset:5376
    s_waitcnt lgkmcnt(8)
    v_mfma_f32_32x32x16_bf16 v[144:159], v[196:199], v[20:23], v[144:159]
    v_lshlrev_b32 v184, 16, v216
    v_and_b32 v185, 0xffff0000, v216
    v_mul_f32 v216, s92, v168
    v_exp_f32 v216, v216
    ds_read_b64_tr_b16 v[192:193], v2 offset:6144
    ds_read_b64_tr_b16 v[194:195], v2 offset:6400
    s_waitcnt lgkmcnt(8)
    v_mfma_f32_32x32x16_bf16 v[144:159], v[200:203], v[24:27], v[144:159]
    s_nop 0
    v_add_f32 v216, 1.0, v216
    v_rcp_f32 v216, v216
    s_nop 0
    ds_read_b64_tr_b16 v[196:197], v2 offset:7168
    ds_read_b64_tr_b16 v[198:199], v2 offset:7424
    s_waitcnt lgkmcnt(8)
    v_mfma_f32_32x32x16_bf16 v[144:159], v[204:207], v[28:31], v[144:159]
    v_mul_f32 v168, v168, v216
    v_mul_f32 v217, s92, v169
    v_exp_f32 v217, v217
    s_nop 0
    ds_read_b64_tr_b16 v[200:201], v2 offset:8192
    ds_read_b64_tr_b16 v[202:203], v2 offset:8448
    s_waitcnt lgkmcnt(8)
    v_mfma_f32_32x32x16_bf16 v[144:159], v[208:211], v[32:35], v[144:159]
    v_add_f32 v217, 1.0, v217
    v_rcp_f32 v217, v217
    s_nop 0
    v_mul_f32 v169, v169, v217
    ds_read_b64_tr_b16 v[204:205], v2 offset:9216
    ds_read_b64_tr_b16 v[206:207], v2 offset:9472
    s_waitcnt lgkmcnt(8)
    v_mfma_f32_32x32x16_bf16 v[144:159], v[212:215], v[36:39], v[144:159]
    v_cvt_pk_bf16_f32 v216, v168, v169
    v_lshlrev_b32 v168, 16, v216
    v_and_b32 v169, 0xffff0000, v216
    v_mul_f32 v168, v168, v184
    ds_read_b64_tr_b16 v[208:209], v2 offset:10240
    ds_read_b64_tr_b16 v[210:211], v2 offset:10496
    s_waitcnt lgkmcnt(8)
    v_mfma_f32_32x32x16_bf16 v[144:159], v[192:195], v[40:43], v[144:159]
    v_mul_f32 v169, v169, v185
    v_cvt_pk_bf16_f32 v228, v168, v169
    v_cvt_pk_bf16_f32 v216, v170, v171
    v_lshlrev_b32 v170, 16, v216
    ds_read_b64_tr_b16 v[212:213], v2 offset:11264
    ds_read_b64_tr_b16 v[214:215], v2 offset:11520
    s_waitcnt lgkmcnt(8)
    v_mfma_f32_32x32x16_bf16 v[144:159], v[196:199], v[44:47], v[144:159]
    v_and_b32 v171, 0xffff0000, v216
    v_cvt_pk_bf16_f32 v216, v186, v187
    v_lshlrev_b32 v186, 16, v216
    v_and_b32 v187, 0xffff0000, v216
    ds_read_b64_tr_b16 v[192:193], v2 offset:12288
    ds_read_b64_tr_b16 v[194:195], v2 offset:12544
    s_waitcnt lgkmcnt(8)
    v_mfma_f32_32x32x16_bf16 v[144:159], v[200:203], v[48:51], v[144:159]
    v_mul_f32 v216, s92, v170
    v_exp_f32 v216, v216
    s_nop 0
    v_add_f32 v216, 1.0, v216
    ds_read_b64_tr_b16 v[196:197], v2 offset:13312
    ds_read_b64_tr_b16 v[198:199], v2 offset:13568
    s_waitcnt lgkmcnt(8)
    v_mfma_f32_32x32x16_bf16 v[144:159], v[204:207], v[52:55], v[144:159]
    v_rcp_f32 v216, v216
    s_nop 0
    v_mul_f32 v170, v170, v216
    v_mul_f32 v217, s92, v171
    ds_read_b64_tr_b16 v[200:201], v2 offset:14336
    ds_read_b64_tr_b16 v[202:203], v2 offset:14592
    s_waitcnt lgkmcnt(8)
    v_mfma_f32_32x32x16_bf16 v[144:159], v[208:211], v[56:59], v[144:159]
    v_exp_f32 v217, v217
    s_nop 0
    v_add_f32 v217, 1.0, v217
    v_rcp_f32 v217, v217
    ds_read_b64_tr_b16 v[204:205], v2 offset:15360
    ds_read_b64_tr_b16 v[206:207], v2 offset:15616
    s_waitcnt lgkmcnt(8)
    v_mfma_f32_32x32x16_bf16 v[144:159], v[212:215], v[60:63], v[144:159]
    s_nop 0
    v_mul_f32 v171, v171, v217
    v_cvt_pk_bf16_f32 v216, v170, v171
    v_lshlrev_b32 v170, 16, v216
    ds_read_b64_tr_b16 v[208:209], v2 offset:16384
    ds_read_b64_tr_b16 v[210:211], v2 offset:16640
    s_waitcnt lgkmcnt(8)
    v_mfma_f32_32x32x16_bf16 v[144:159], v[192:195], v[64:67], v[144:159]
    v_and_b32 v171, 0xffff0000, v216
    v_mul_f32 v170, v170, v186
    v_mul_f32 v171, v171, v187
    v_cvt_pk_bf16_f32 v229, v170, v171
    ds_read_b64_tr_b16 v[212:213], v2 offset:17408
    ds_read_b64_tr_b16 v[214:215], v2 offset:17664
    s_waitcnt lgkmcnt(8)
    v_mfma_f32_32x32x16_bf16 v[144:159], v[196:199], v[68:71], v[144:159]
    v_cvt_pk_bf16_f32 v216, v172, v173
    v_lshlrev_b32 v172, 16, v216
    v_and_b32 v173, 0xffff0000, v216
    v_cvt_pk_bf16_f32 v216, v188, v189
    ds_read_b64_tr_b16 v[192:193], v2 offset:18432
    ds_read_b64_tr_b16 v[194:195], v2 offset:18688
    s_waitcnt lgkmcnt(8)
    v_mfma_f32_32x32x16_bf16 v[144:159], v[200:203], v[72:75], v[144:159]
    v_lshlrev_b32 v188, 16, v216
    v_and_b32 v189, 0xffff0000, v216
    v_mul_f32 v216, s92, v172
    v_exp_f32 v216, v216
    ds_read_b64_tr_b16 v[196:197], v2 offset:19456
    ds_read_b64_tr_b16 v[198:199], v2 offset:19712
    s_waitcnt lgkmcnt(8)
    v_mfma_f32_32x32x16_bf16 v[144:159], v[204:207], v[76:79], v[144:159]
    s_nop 0
    v_add_f32 v216, 1.0, v216
    v_rcp_f32 v216, v216
    s_nop 0
    ds_read_b64_tr_b16 v[200:201], v2 offset:20480
    ds_read_b64_tr_b16 v[202:203], v2 offset:20736
    s_waitcnt lgkmcnt(8)
    v_mfma_f32_32x32x16_bf16 v[144:159], v[208:211], v[80:83], v[144:159]
    v_mul_f32 v172, v172, v216
    v_mul_f32 v217, s92, v173
    v_exp_f32 v217, v217
    s_nop 0
    ds_read_b64_tr_b16 v[204:205], v2 offset:21504
    ds_read_b64_tr_b16 v[206:207], v2 offset:21760
    s_waitcnt lgkmcnt(8)
    v_mfma_f32_32x32x16_bf16 v[144:159], v[212:215], v[84:87], v[144:159]
    v_add_f32 v217, 1.0, v217
    v_rcp_f32 v217, v217
    s_nop 0
    v_mul_f32 v173, v173, v217
    ds_read_b64_tr_b16 v[208:209], v2 offset:22528
    ds_read_b64_tr_b16 v[210:211], v2 offset:22784
    s_waitcnt lgkmcnt(8)
    v_mfma_f32_32x32x16_bf16 v[144:159], v[192:195], v[88:91], v[144:159]
    v_cvt_pk_bf16_f32 v216, v172, v173
    v_lshlrev_b32 v172, 16, v216
    v_and_b32 v173, 0xffff0000, v216
    v_mul_f32 v172, v172, v188
    ds_read_b64_tr_b16 v[212:213], v2 offset:23552
    ds_read_b64_tr_b16 v[214:215], v2 offset:23808
    s_waitcnt lgkmcnt(8)
    v_mfma_f32_32x32x16_bf16 v[144:159], v[196:199], v[92:95], v[144:159]
    v_mul_f32 v173, v173, v189
    v_cvt_pk_bf16_f32 v230, v172, v173
    v_cvt_pk_bf16_f32 v216, v174, v175
    v_lshlrev_b32 v174, 16, v216
    ds_read_b64_tr_b16 v[192:193], v2 offset:24576
    ds_read_b64_tr_b16 v[194:195], v2 offset:24832
    s_waitcnt lgkmcnt(8)
    v_mfma_f32_32x32x16_bf16 v[144:159], v[200:203], v[96:99], v[144:159]
    v_and_b32 v175, 0xffff0000, v216
    v_cvt_pk_bf16_f32 v216, v190, v191
    v_lshlrev_b32 v190, 16, v216
    v_and_b32 v191, 0xffff0000, v216
    ds_read_b64_tr_b16 v[196:197], v2 offset:25600
    ds_read_b64_tr_b16 v[198:199], v2 offset:25856
    s_waitcnt lgkmcnt(8)
    v_mfma_f32_32x32x16_bf16 v[144:159], v[204:207], v[100:103], v[144:159]
    v_mul_f32 v216, s92, v174
    v_exp_f32 v216, v216
    s_nop 0
    v_add_f32 v216, 1.0, v216
    ds_read_b64_tr_b16 v[200:201], v2 offset:26624
    ds_read_b64_tr_b16 v[202:203], v2 offset:26880
    s_waitcnt lgkmcnt(8)
    v_mfma_f32_32x32x16_bf16 v[144:159], v[208:211], v[104:107], v[144:159]
    v_rcp_f32 v216, v216
    s_nop 0
    v_mul_f32 v174, v174, v216
    v_mul_f32 v217, s92, v175
    ds_read_b64_tr_b16 v[204:205], v2 offset:27648
    ds_read_b64_tr_b16 v[206:207], v2 offset:27904
    s_waitcnt lgkmcnt(8)
    v_mfma_f32_32x32x16_bf16 v[144:159], v[212:215], v[108:111], v[144:159]
    v_exp_f32 v217, v217
    s_nop 0
    v_add_f32 v217, 1.0, v217
    v_rcp_f32 v217, v217
    s_waitcnt lgkmcnt(6)
    v_mfma_f32_32x32x16_bf16 v[144:159], v[192:195], v[112:115], v[144:159]
    s_nop 0
    v_mul_f32 v175, v175, v217
    v_cvt_pk_bf16_f32 v216, v174, v175
    v_lshlrev_b32 v174, 16, v216
    s_waitcnt lgkmcnt(4)
    v_mfma_f32_32x32x16_bf16 v[144:159], v[196:199], v[116:119], v[144:159]
    v_and_b32 v175, 0xffff0000, v216
    v_mul_f32 v174, v174, v190
    v_mul_f32 v175, v175, v191
    v_cvt_pk_bf16_f32 v231, v174, v175
    s_waitcnt lgkmcnt(2)
    v_mfma_f32_32x32x16_bf16 v[144:159], v[200:203], v[120:123], v[144:159]
    s_movk_i32 s39, 4096
    buffer_store_dwordx4 v[224:227], v15, s[24:27], s39 offen
    buffer_store_dwordx4 v[228:231], v15, s[24:27], s39 offen offset:1024
    s_nop 1
    s_waitcnt lgkmcnt(0)
    v_mfma_f32_32x32x16_bf16 v[144:159], v[204:207], v[124:127], v[144:159]
    s_nop 15
    s_nop 3
    v_cvt_pk_bf16_f32 v216, v128, v129
    v_lshlrev_b32 v128, 16, v216
    v_and_b32 v129, 0xffff0000, v216
    v_cvt_pk_bf16_f32 v216, v144, v145
    v_lshlrev_b32 v144, 16, v216
    v_and_b32 v145, 0xffff0000, v216
    v_mul_f32 v216, s92, v128
    v_exp_f32 v216, v216
    s_nop 0
    v_add_f32 v216, 1.0, v216
    v_rcp_f32 v216, v216
    s_nop 0
    v_mul_f32 v128, v128, v216
    v_mul_f32 v217, s92, v129
    v_exp_f32 v217, v217
    s_nop 0
    v_add_f32 v217, 1.0, v217
    v_rcp_f32 v217, v217
    s_nop 0
    v_mul_f32 v129, v129, v217
    v_cvt_pk_bf16_f32 v216, v128, v129
    v_lshlrev_b32 v128, 16, v216
    v_and_b32 v129, 0xffff0000, v216
    v_mul_f32 v128, v128, v144
    v_mul_f32 v129, v129, v145
    v_cvt_pk_bf16_f32 v224, v128, v129
    v_cvt_pk_bf16_f32 v216, v130, v131
    v_lshlrev_b32 v130, 16, v216
    v_and_b32 v131, 0xffff0000, v216
    v_cvt_pk_bf16_f32 v216, v146, v147
    v_lshlrev_b32 v146, 16, v216
    v_and_b32 v147, 0xffff0000, v216
    v_mul_f32 v216, s92, v130
    v_exp_f32 v216, v216
    s_nop 0
    v_add_f32 v216, 1.0, v216
    v_rcp_f32 v216, v216
    s_nop 0
    v_mul_f32 v130, v130, v216
    v_mul_f32 v217, s92, v131
    v_exp_f32 v217, v217
    s_nop 0
    v_add_f32 v217, 1.0, v217
    v_rcp_f32 v217, v217
    s_nop 0
    v_mul_f32 v131, v131, v217
    v_cvt_pk_bf16_f32 v216, v130, v131
    v_lshlrev_b32 v130, 16, v216
    v_and_b32 v131, 0xffff0000, v216
    v_mul_f32 v130, v130, v146
    v_mul_f32 v131, v131, v147
    v_cvt_pk_bf16_f32 v225, v130, v131
    v_cvt_pk_bf16_f32 v216, v132, v133
    v_lshlrev_b32 v132, 16, v216
    v_and_b32 v133, 0xffff0000, v216
    v_cvt_pk_bf16_f32 v216, v148, v149
    v_lshlrev_b32 v148, 16, v216
    v_and_b32 v149, 0xffff0000, v216
    v_mul_f32 v216, s92, v132
    v_exp_f32 v216, v216
    s_nop 0
    v_add_f32 v216, 1.0, v216
    v_rcp_f32 v216, v216
    s_nop 0
    v_mul_f32 v132, v132, v216
    v_mul_f32 v217, s92, v133
    v_exp_f32 v217, v217
    s_nop 0
    v_add_f32 v217, 1.0, v217
    v_rcp_f32 v217, v217
    s_nop 0
    v_mul_f32 v133, v133, v217
    v_cvt_pk_bf16_f32 v216, v132, v133
    v_lshlrev_b32 v132, 16, v216
    v_and_b32 v133, 0xffff0000, v216
    v_mul_f32 v132, v132, v148
    v_mul_f32 v133, v133, v149
    v_cvt_pk_bf16_f32 v226, v132, v133
    v_cvt_pk_bf16_f32 v216, v134, v135
    v_lshlrev_b32 v134, 16, v216
    v_and_b32 v135, 0xffff0000, v216
    v_cvt_pk_bf16_f32 v216, v150, v151
    v_lshlrev_b32 v150, 16, v216
    v_and_b32 v151, 0xffff0000, v216
    v_mul_f32 v216, s92, v134
    v_exp_f32 v216, v216
    s_nop 0
    v_add_f32 v216, 1.0, v216
    v_rcp_f32 v216, v216
    s_nop 0
    v_mul_f32 v134, v134, v216
    v_mul_f32 v217, s92, v135
    v_exp_f32 v217, v217
    s_nop 0
    v_add_f32 v217, 1.0, v217
    v_rcp_f32 v217, v217
    s_nop 0
    v_mul_f32 v135, v135, v217
    v_cvt_pk_bf16_f32 v216, v134, v135
    v_lshlrev_b32 v134, 16, v216
    v_and_b32 v135, 0xffff0000, v216
    v_mul_f32 v134, v134, v150
    v_mul_f32 v135, v135, v151
    v_cvt_pk_bf16_f32 v227, v134, v135
    v_cvt_pk_bf16_f32 v216, v136, v137
    v_lshlrev_b32 v136, 16, v216
    v_and_b32 v137, 0xffff0000, v216
    v_cvt_pk_bf16_f32 v216, v152, v153
    v_lshlrev_b32 v152, 16, v216
    v_and_b32 v153, 0xffff0000, v216
    v_mul_f32 v216, s92, v136
    v_exp_f32 v216, v216
    s_nop 0
    v_add_f32 v216, 1.0, v216
    v_rcp_f32 v216, v216
    s_nop 0
    v_mul_f32 v136, v136, v216
    v_mul_f32 v217, s92, v137
    v_exp_f32 v217, v217
    s_nop 0
    v_add_f32 v217, 1.0, v217
    v_rcp_f32 v217, v217
    s_nop 0
    v_mul_f32 v137, v137, v217
    v_cvt_pk_bf16_f32 v216, v136, v137
    v_lshlrev_b32 v136, 16, v216
    v_and_b32 v137, 0xffff0000, v216
    v_mul_f32 v136, v136, v152
    v_mul_f32 v137, v137, v153
    v_cvt_pk_bf16_f32 v228, v136, v137
    v_cvt_pk_bf16_f32 v216, v138, v139
    v_lshlrev_b32 v138, 16, v216
    v_and_b32 v139, 0xffff0000, v216
    v_cvt_pk_bf16_f32 v216, v154, v155
    v_lshlrev_b32 v154, 16, v216
    v_and_b32 v155, 0xffff0000, v216
    v_mul_f32 v216, s92, v138
    v_exp_f32 v216, v216
    s_nop 0
    v_add_f32 v216, 1.0, v216
    v_rcp_f32 v216, v216
    s_nop 0
    v_mul_f32 v138, v138, v216
    v_mul_f32 v217, s92, v139
    v_exp_f32 v217, v217
    s_nop 0
    v_add_f32 v217, 1.0, v217
    v_rcp_f32 v217, v217
    s_nop 0
    v_mul_f32 v139, v139, v217
    v_cvt_pk_bf16_f32 v216, v138, v139
    v_lshlrev_b32 v138, 16, v216
    v_and_b32 v139, 0xffff0000, v216
    v_mul_f32 v138, v138, v154
    v_mul_f32 v139, v139, v155
    v_cvt_pk_bf16_f32 v229, v138, v139
    v_cvt_pk_bf16_f32 v216, v140, v141
    v_lshlrev_b32 v140, 16, v216
    v_and_b32 v141, 0xffff0000, v216
    v_cvt_pk_bf16_f32 v216, v156, v157
    v_lshlrev_b32 v156, 16, v216
    v_and_b32 v157, 0xffff0000, v216
    v_mul_f32 v216, s92, v140
    v_exp_f32 v216, v216
    s_nop 0
    v_add_f32 v216, 1.0, v216
    v_rcp_f32 v216, v216
    s_nop 0
    v_mul_f32 v140, v140, v216
    v_mul_f32 v217, s92, v141
    v_exp_f32 v217, v217
    s_nop 0
    v_add_f32 v217, 1.0, v217
    v_rcp_f32 v217, v217
    s_nop 0
    v_mul_f32 v141, v141, v217
    v_cvt_pk_bf16_f32 v216, v140, v141
    v_lshlrev_b32 v140, 16, v216
    v_and_b32 v141, 0xffff0000, v216
    v_mul_f32 v140, v140, v156
    v_mul_f32 v141, v141, v157
    v_cvt_pk_bf16_f32 v230, v140, v141
    v_cvt_pk_bf16_f32 v216, v142, v143
    v_lshlrev_b32 v142, 16, v216
    v_and_b32 v143, 0xffff0000, v216
    v_cvt_pk_bf16_f32 v216, v158, v159
    v_lshlrev_b32 v158, 16, v216
    v_and_b32 v159, 0xffff0000, v216
    v_mul_f32 v216, s92, v142
    v_exp_f32 v216, v216
    s_nop 0
    v_add_f32 v216, 1.0, v216
    v_rcp_f32 v216, v216
    s_nop 0
    v_mul_f32 v142, v142, v216
    v_mul_f32 v217, s92, v143
    v_exp_f32 v217, v217
    s_nop 0
    v_add_f32 v217, 1.0, v217
    v_rcp_f32 v217, v217
    s_nop 0
    v_mul_f32 v143, v143, v217
    v_cvt_pk_bf16_f32 v216, v142, v143
    v_lshlrev_b32 v142, 16, v216
    v_and_b32 v143, 0xffff0000, v216
    v_mul_f32 v142, v142, v158
    v_mul_f32 v143, v143, v159
    v_cvt_pk_bf16_f32 v231, v142, v143
    s_movk_i32 s39, 6144
    buffer_store_dwordx4 v[224:227], v15, s[24:27], s39 offen
    s_nop 1
K1_done:
    s_endpgm
.globl k2_kernel
.p2align 8
.type k2_kernel,@function
k2_kernel:
    s_cmp_ge_u32 s2, 224
    s_cbranch_scc1 K2_done
    s_load_dwordx2 s[12:13], s[0:1], 0
    s_load_dwordx2 s[16:17], s[0:1], 56
    s_load_dwordx2 s[24:25], s[0:1], 72
    s_mov_b32 s90, 1069066811
    s_mov_b32 s91, 897988541
    s_mov_b32 s92, 3216550459
    v_and_b32 v1, 63, v0
    v_lshrrev_b32 v2, 6, v0
    s_nop 0
    v_readfirstlane_b32 s6, v2
    s_waitcnt lgkmcnt(0)
    s_and_b32 s13, s13, 0xffff
    s_mov_b32 s14, 1835008
    s_mov_b32 s15, 0x20000
    s_and_b32 s17, s17, 0xffff
    s_mov_b32 s18, 1835008
    s_mov_b32 s19, 0x20000
    s_and_b32 s25, s25, 0xffff
    s_mov_b32 s26, 67108864
    s_mov_b32 s27, 0x20000
K2_gemm:
    s_and_b32 s4, s2, 31
    s_lshr_b32 s5, s2, 5
    v_and_b32 v3, 31, v1
    v_lshrrev_b32 v4, 5, v1
    s_lshl_b32 s7, s4, 6
    v_lshlrev_b32 v5, 4, v1
    s_mul_i32 s30, s4, 229376
    s_mul_i32 s33, s6, 14336
    s_add_u32 s30, s30, s33
    s_add_u32 s30, s30, 2097152
    v_add_u32 v5, s30, v5
    v_add_u32 v8, 114688, v5
    v_lshrrev_b32 v6, 5, v1
    v_lshlrev_b32 v6, 9, v6
    v_bfe_u32 v7, v1, 2, 2
    v_lshl_add_u32 v6, v7, 6, v6
    v_bfe_u32 v7, v1, 4, 1
    v_lshl_add_u32 v6, v7, 5, v6
    v_and_b32 v7, 3, v1
    v_lshl_add_u32 v6, v7, 3, v6
    s_lshl_b32 s31, s6, 14
    v_add_u32 v6, s31, v6
    v_bfe_u32 v7, v1, 4, 1
    v_lshlrev_b32 v7, 3, v7
    v_lshrrev_b32 v9, 5, v1
    v_lshl_add_u32 v7, v9, 2, v7
    v_bfe_u32 v9, v1, 2, 2
    v_add_u32 v7, v7, v9
    s_movk_i32 s30, 896
    v_mul_lo_u32 v7, v7, s30
    v_and_b32 v9, 3, v1
    v_lshl_add_u32 v7, v9, 4, v7
    v_lshlrev_b32 v7, 4, v1
    s_mul_i32 s32, s6, 28672
    s_mul_i32 s30, s5, 229376
    s_add_u32 s32, s32, s30
    s_add_u32 s32, s32, 23068672
    v_mov_b32 v64, 0
    v_mov_b32 v65, 0
    v_mov_b32 v66, 0
    v_mov_b32 v67, 0
    v_mov_b32 v68, 0
    v_mov_b32 v69, 0
    v_mov_b32 v70, 0
    v_mov_b32 v71, 0
    v_mov_b32 v72, 0
    v_mov_b32 v73, 0
    v_mov_b32 v74, 0
    v_mov_b32 v75, 0
    v_mov_b32 v76, 0
    v_mov_b32 v77, 0
    v_mov_b32 v78, 0
    v_mov_b32 v79, 0
    v_mov_b32 v80, 0
    v_mov_b32 v81, 0
    v_mov_b32 v82, 0
    v_mov_b32 v83, 0
    v_mov_b32 v84, 0
    v_mov_b32 v85, 0
    v_mov_b32 v86, 0
    v_mov_b32 v87, 0
    v_mov_b32 v88, 0
    v_mov_b32 v89, 0
    v_mov_b32 v90, 0
    v_mov_b32 v91, 0
    v_mov_b32 v92, 0
    v_mov_b32 v93, 0
    v_mov_b32 v94, 0
    v_mov_b32 v95, 0
    v_mov_b32 v96, 0
    v_mov_b32 v97, 0
    v_mov_b32 v98, 0
    v_mov_b32 v99, 0
    v_mov_b32 v100, 0
    v_mov_b32 v101, 0
    v_mov_b32 v102, 0
    v_mov_b32 v103, 0
    v_mov_b32 v104, 0
    v_mov_b32 v105, 0
    v_mov_b32 v106, 0
    v_mov_b32 v107, 0
    v_mov_b32 v108, 0
    v_mov_b32 v109, 0
    v_mov_b32 v110, 0
    v_mov_b32 v111, 0
    v_mov_b32 v112, 0
    v_mov_b32 v113, 0
    v_mov_b32 v114, 0
    v_mov_b32 v115, 0
    v_mov_b32 v116, 0
    v_mov_b32 v117, 0
    v_mov_b32 v118, 0
    v_mov_b32 v119, 0
    v_mov_b32 v120, 0
    v_mov_b32 v121, 0
    v_mov_b32 v122, 0
    v_mov_b32 v123, 0
    v_mov_b32 v124, 0
    v_mov_b32 v125, 0
    v_mov_b32 v126, 0
    v_mov_b32 v127, 0
    v_lshlrev_b32 v9, 4, v1
    v_lshlrev_b32 v12, 5, v1
    s_lshl_b32 s30, s4, 1
    s_add_u32 s30, s30, 0
    s_lshl_b32 s30, s30, 15
    s_lshl_b32 s33, s6, 12
    s_add_u32 s30, s30, s33
    s_add_u32 s30, s30, 0
    buffer_load_dwordx4 v[16:19], v9, s[24:27], s30 offen
    buffer_load_dwordx4 v[20:23], v9, s[24:27], s30 offen offset:1024
    s_lshl_b32 s30, s4, 1
    s_add_u32 s30, s30, 0
    s_lshl_b32 s30, s30, 15
    s_lshl_b32 s33, s6, 12
    s_add_u32 s30, s30, s33
    s_add_u32 s30, s30, 2048
    buffer_load_dwordx4 v[24:27], v9, s[24:27], s30 offen
    buffer_load_dwordx4 v[28:31], v9, s[24:27], s30 offen offset:1024
    s_lshl_b32 s30, s4, 1
    s_add_u32 s30, s30, 1
    s_lshl_b32 s30, s30, 15
    s_lshl_b32 s33, s6, 12
    s_add_u32 s30, s30, s33
    s_add_u32 s30, s30, 0
    buffer_load_dwordx4 v[32:35], v9, s[24:27], s30 offen
    buffer_load_dwordx4 v[36:39], v9, s[24:27], s30 offen offset:1024
    s_lshl_b32 s30, s4, 1
    s_add_u32 s30, s30, 1
    s_lshl_b32 s30, s30, 15
    s_lshl_b32 s33, s6, 12
    s_add_u32 s30, s30, s33
    s_add_u32 s30, s30, 2048
    buffer_load_dwordx4 v[40:43], v9, s[24:27], s30 offen
    buffer_load_dwordx4 v[44:47], v9, s[24:27], s30 offen offset:1024
    s_lshl_b32 s30, s6, 12
    s_add_u32 s30, s30, 11534336
    buffer_load_dwordx4 v[48:51], v12, s[24:27], s30 offen
    buffer_load_dwordx4 v[52:55], v12, s[24:27], s30 offen offset:16
    s_lshl_b32 s30, s6, 12
    s_add_u32 s30, s30, 11536384
    buffer_load_dwordx4 v[56:59], v12, s[24:27], s30 offen
    buffer_load_dwordx4 v[60:63], v12, s[24:27], s30 offen offset:16
    s_add_u32 s30, s31, 0
    s_mov_b32 m0, s30
    s_add_u32 s30, s32, 0
    buffer_load_dwordx4 v7, s[24:27], s30 offen lds
    s_add_u32 s30, s31, 1024
    s_mov_b32 m0, s30
    s_add_u32 s30, s32, 1024
    buffer_load_dwordx4 v7, s[24:27], s30 offen lds
    s_movk_i32 s30, 0
    buffer_load_dwordx4 v[128:131], v5, s[24:27], s30 offen
    buffer_load_dwordx4 v[132:135], v8, s[24:27], s30 offen
    s_add_u32 s30, s31, 2048
    s_mov_b32 m0, s30
    s_add_u32 s30, s32, 2048
    buffer_load_dwordx4 v7, s[24:27], s30 offen lds
    s_add_u32 s30, s31, 3072
    s_mov_b32 m0, s30
    s_add_u32 s30, s32, 3072
    buffer_load_dwordx4 v7, s[24:27], s30 offen lds
    s_movk_i32 s30, 1024
    buffer_load_dwordx4 v[136:139], v5, s[24:27], s30 offen
    buffer_load_dwordx4 v[140:143], v8, s[24:27], s30 offen
    s_add_u32 s30, s31, 4096
    s_mov_b32 m0, s30
    s_add_u32 s30, s32, 4096
    buffer_load_dwordx4 v7, s[24:27], s30 offen lds
    s_add_u32 s30, s31, 5120
    s_mov_b32 m0, s30
    s_add_u32 s30, s32, 5120
    buffer_load_dwordx4 v7, s[24:27], s30 offen lds
    s_movk_i32 s30, 2048
    buffer_load_dwordx4 v[144:147], v5, s[24:27], s30 offen
    buffer_load_dwordx4 v[148:151], v8, s[24:27], s30 offen
    s_add_u32 s30, s31, 6144
    s_mov_b32 m0, s30
    s_add_u32 s30, s32, 6144
    buffer_load_dwordx4 v7, s[24:27], s30 offen lds
    s_add_u32 s30, s31, 7168
    s_mov_b32 m0, s30
    s_add_u32 s30, s32, 7168
    buffer_load_dwordx4 v7, s[24:27], s30 offen lds
    s_movk_i32 s30, 3072
    buffer_load_dwordx4 v[152:155], v5, s[24:27], s30 offen
    buffer_load_dwordx4 v[156:159], v8, s[24:27], s30 offen
    s_add_u32 s30, s31, 8192
    s_mov_b32 m0, s30
    s_add_u32 s30, s32, 8192
    buffer_load_dwordx4 v7, s[24:27], s30 offen lds
    s_add_u32 s30, s31, 9216
    s_mov_b32 m0, s30
    s_add_u32 s30, s32, 9216
    buffer_load_dwordx4 v7, s[24:27], s30 offen lds
    s_movk_i32 s30, 4096
    buffer_load_dwordx4 v[160:163], v5, s[24:27], s30 offen
    buffer_load_dwordx4 v[164:167], v8, s[24:27], s30 offen
    s_add_u32 s30, s31, 10240
    s_mov_b32 m0, s30
    s_add_u32 s30, s32, 10240
    buffer_load_dwordx4 v7, s[24:27], s30 offen lds
    s_add_u32 s30, s31, 11264
    s_mov_b32 m0, s30
    s_add_u32 s30, s32, 11264
    buffer_load_dwordx4 v7, s[24:27], s30 offen lds
    s_movk_i32 s30, 5120
    buffer_load_dwordx4 v[168:171], v5, s[24:27], s30 offen
    buffer_load_dwordx4 v[172:175], v8, s[24:27], s30 offen
    s_add_u32 s30, s31, 12288
    s_mov_b32 m0, s30
    s_add_u32 s30, s32, 12288
    buffer_load_dwordx4 v7, s[24:27], s30 offen lds
    s_add_u32 s30, s31, 13312
    s_mov_b32 m0, s30
    s_add_u32 s30, s32, 13312
    buffer_load_dwordx4 v7, s[24:27], s30 offen lds
    s_movk_i32 s30, 6144
    buffer_load_dwordx4 v[176:179], v5, s[24:27], s30 offen
    buffer_load_dwordx4 v[180:183], v8, s[24:27], s30 offen
    s_waitcnt vmcnt(28)
    v_add_u32 v14, 32, v3
    v_lshlrev_b32 v14, 2, v14
    v_mov_b32 v208, 0
    v_mov_b32 v209, 0
    v_mov_b32 v210, 0
    v_mov_b32 v211, 0
    v_mov_b32 v212, 0
    v_mov_b32 v213, 0
    v_mov_b32 v214, 0
    v_mov_b32 v215, 0
    v_mov_b32 v216, 0
    v_mov_b32 v217, 0
    v_mov_b32 v218, 0
    v_mov_b32 v219, 0
    v_mov_b32 v220, 0
    v_mov_b32 v221, 0
    v_mov_b32 v222, 0
    v_mov_b32 v223, 0
    v_mov_b32 v224, 0
    v_mov_b32 v225, 0
    v_mov_b32 v226, 0
    v_mov_b32 v227, 0
    v_mov_b32 v228, 0
    v_mov_b32 v229, 0
    v_mov_b32 v230, 0
    v_mov_b32 v231, 0
    v_mov_b32 v232, 0
    v_mov_b32 v233, 0
    v_mov_b32 v234, 0
    v_mov_b32 v235, 0
    v_mov_b32 v236, 0
    v_mov_b32 v237, 0
    v_mov_b32 v238, 0
    v_mov_b32 v239, 0
    s_nop 1
    v_mfma_f32_32x32x16_bf16 v[208:223], v[48:51], v[16:19], v[208:223]
    v_mfma_f32_32x32x16_bf16 v[208:223], v[52:55], v[20:23], v[208:223]
    v_mfma_f32_32x32x16_bf16 v[224:239], v[56:59], v[24:27], v[224:239]
    v_mfma_f32_32x32x16_bf16 v[224:239], v[60:63], v[28:31], v[224:239]
    s_nop 15
    s_nop 3
    ds_bpermute_b32 v240, v14, v220
    s_waitcnt lgkmcnt(0)
    v_cvt_pk_bf16_f32 v242, v240, v241
    v_lshlrev_b32 v240, 16, v242
    v_and_b32 v241, 0xffff0000, v242
    v_add_f32 v240, s91, v240
    v_cvt_pk_bf16_f32 v242, v240, v241
    v_lshlrev_b32 v240, 16, v242
    v_and_b32 v241, 0xffff0000, v242
    v_rcp_f32 v240, v240
    s_nop 0
    v_cvt_pk_bf16_f32 v242, v208, v209
    v_lshlrev_b32 v208, 16, v242
    v_and_b32 v209, 0xffff0000, v242
    v_mul_f32 v208, v208, v240
    v_mul_f32 v209, v209, v240
    v_cvt_pk_bf16_f32 v16, v208, v209
    v_cvt_pk_bf16_f32 v242, v210, v211
    v_lshlrev_b32 v210, 16, v242
    v_and_b32 v211, 0xffff0000, v242
    v_mul_f32 v210, v210, v240
    v_mul_f32 v211, v211, v240
    v_cvt_pk_bf16_f32 v17, v210, v211
    v_cvt_pk_bf16_f32 v242, v212, v213
    v_lshlrev_b32 v212, 16, v242
    v_and_b32 v213, 0xffff0000, v242
    v_mul_f32 v212, v212, v240
    v_mul_f32 v213, v213, v240
    v_cvt_pk_bf16_f32 v18, v212, v213
    v_cvt_pk_bf16_f32 v242, v214, v215
    v_lshlrev_b32 v214, 16, v242
    v_and_b32 v215, 0xffff0000, v242
    v_mul_f32 v214, v214, v240
    v_mul_f32 v215, v215, v240
    v_cvt_pk_bf16_f32 v19, v214, v215
    v_cvt_pk_bf16_f32 v242, v216, v217
    v_lshlrev_b32 v216, 16, v242
    v_and_b32 v217, 0xffff0000, v242
    v_mul_f32 v216, v216, v240
    v_mul_f32 v217, v217, v240
    v_cvt_pk_bf16_f32 v20, v216, v217
    v_cvt_pk_bf16_f32 v242, v218, v219
    v_lshlrev_b32 v218, 16, v242
    v_and_b32 v219, 0xffff0000, v242
    v_mul_f32 v218, v218, v240
    v_mul_f32 v219, v219, v240
    v_cvt_pk_bf16_f32 v21, v218, v219
    v_cvt_pk_bf16_f32 v242, v220, v221
    v_lshlrev_b32 v220, 16, v242
    v_and_b32 v221, 0xffff0000, v242
    v_mul_f32 v220, v220, v240
    v_mul_f32 v221, v221, v240
    v_cvt_pk_bf16_f32 v22, v220, v221
    v_cvt_pk_bf16_f32 v242, v222, v223
    v_lshlrev_b32 v222, 16, v242
    v_and_b32 v223, 0xffff0000, v242
    v_mul_f32 v222, v222, v240
    v_mul_f32 v223, v223, v240
    v_cvt_pk_bf16_f32 v23, v222, v223
    v_cmp_eq_u32 vcc, 0, v4
    s_nop 1
    v_cndmask_b32 v22, 0, v22, vcc
    v_cndmask_b32 v23, 0, v23, vcc
    ds_bpermute_b32 v240, v14, v236
    s_waitcnt lgkmcnt(0)
    v_cvt_pk_bf16_f32 v242, v240, v241
    v_lshlrev_b32 v240, 16, v242
    v_and_b32 v241, 0xffff0000, v242
    v_add_f32 v240, s91, v240
    v_cvt_pk_bf16_f32 v242, v240, v241
    v_lshlrev_b32 v240, 16, v242
    v_and_b32 v241, 0xffff0000, v242
    v_rcp_f32 v240, v240
    s_nop 0
    v_cvt_pk_bf16_f32 v242, v224, v225
    v_lshlrev_b32 v224, 16, v242
    v_and_b32 v225, 0xffff0000, v242
    v_mul_f32 v224, v224, v240
    v_mul_f32 v225, v225, v240
    v_cvt_pk_bf16_f32 v24, v224, v225
    v_cvt_pk_bf16_f32 v242, v226, v227
    v_lshlrev_b32 v226, 16, v242
    v_and_b32 v227, 0xffff0000, v242
    v_mul_f32 v226, v226, v240
    v_mul_f32 v227, v227, v240
    v_cvt_pk_bf16_f32 v25, v226, v227
    v_cvt_pk_bf16_f32 v242, v228, v229
    v_lshlrev_b32 v228, 16, v242
    v_and_b32 v229, 0xffff0000, v242
    v_mul_f32 v228, v228, v240
    v_mul_f32 v229, v229, v240
    v_cvt_pk_bf16_f32 v26, v228, v229
    v_cvt_pk_bf16_f32 v242, v230, v231
    v_lshlrev_b32 v230, 16, v242
    v_and_b32 v231, 0xffff0000, v242
    v_mul_f32 v230, v230, v240
    v_mul_f32 v231, v231, v240
    v_cvt_pk_bf16_f32 v27, v230, v231
    v_cvt_pk_bf16_f32 v242, v232, v233
    v_lshlrev_b32 v232, 16, v242
    v_and_b32 v233, 0xffff0000, v242
    v_mul_f32 v232, v232, v240
    v_mul_f32 v233, v233, v240
    v_cvt_pk_bf16_f32 v28, v232, v233
    v_cvt_pk_bf16_f32 v242, v234, v235
    v_lshlrev_b32 v234, 16, v242
    v_and_b32 v235, 0xffff0000, v242
    v_mul_f32 v234, v234, v240
    v_mul_f32 v235, v235, v240
    v_cvt_pk_bf16_f32 v29, v234, v235
    v_cvt_pk_bf16_f32 v242, v236, v237
    v_lshlrev_b32 v236, 16, v242
    v_and_b32 v237, 0xffff0000, v242
    v_mul_f32 v236, v236, v240
    v_mul_f32 v237, v237, v240
    v_cvt_pk_bf16_f32 v30, v236, v237
    v_cvt_pk_bf16_f32 v242, v238, v239
    v_lshlrev_b32 v238, 16, v242
    v_and_b32 v239, 0xffff0000, v242
    v_mul_f32 v238, v238, v240
    v_mul_f32 v239, v239, v240
    v_cvt_pk_bf16_f32 v31, v238, v239
    v_cmp_eq_u32 vcc, 0, v4
    s_nop 1
    v_cndmask_b32 v30, 0, v30, vcc
    v_cndmask_b32 v31, 0, v31, vcc
    v_mov_b32 v208, 0
    v_mov_b32 v209, 0
    v_mov_b32 v210, 0
    v_mov_b32 v211, 0
    v_mov_b32 v212, 0
    v_mov_b32 v213, 0
    v_mov_b32 v214, 0
    v_mov_b32 v215, 0
    v_mov_b32 v216, 0
    v_mov_b32 v217, 0
    v_mov_b32 v218, 0
    v_mov_b32 v219, 0
    v_mov_b32 v220, 0
    v_mov_b32 v221, 0
    v_mov_b32 v222, 0
    v_mov_b32 v223, 0
    v_mov_b32 v224, 0
    v_mov_b32 v225, 0
    v_mov_b32 v226, 0
    v_mov_b32 v227, 0
    v_mov_b32 v228, 0
    v_mov_b32 v229, 0
    v_mov_b32 v230, 0
    v_mov_b32 v231, 0
    v_mov_b32 v232, 0
    v_mov_b32 v233, 0
    v_mov_b32 v234, 0
    v_mov_b32 v235, 0
    v_mov_b32 v236, 0
    v_mov_b32 v237, 0
    v_mov_b32 v238, 0
    v_mov_b32 v239, 0
    s_nop 1
    v_mfma_f32_32x32x16_bf16 v[208:223], v[48:51], v[32:35], v[208:223]
    v_mfma_f32_32x32x16_bf16 v[208:223], v[52:55], v[36:39], v[208:223]
    v_mfma_f32_32x32x16_bf16 v[224:239], v[56:59], v[40:43], v[224:239]
    v_mfma_f32_32x32x16_bf16 v[224:239], v[60:63], v[44:47], v[224:239]
    s_nop 15
    s_nop 3
    ds_bpermute_b32 v240, v14, v220
    s_waitcnt lgkmcnt(0)
    v_cvt_pk_bf16_f32 v242, v240, v241
    v_lshlrev_b32 v240, 16, v242
    v_and_b32 v241, 0xffff0000, v242
    v_add_f32 v240, s91, v240
    v_cvt_pk_bf16_f32 v242, v240, v241
    v_lshlrev_b32 v240, 16, v242
    v_and_b32 v241, 0xffff0000, v242
    v_rcp_f32 v240, v240
    s_nop 0
    v_cvt_pk_bf16_f32 v242, v208, v209
    v_lshlrev_b32 v208, 16, v242
    v_and_b32 v209, 0xffff0000, v242
    v_mul_f32 v208, v208, v240
    v_mul_f32 v209, v209, v240
    v_cvt_pk_bf16_f32 v32, v208, v209
    v_cvt_pk_bf16_f32 v242, v210, v211
    v_lshlrev_b32 v210, 16, v242
    v_and_b32 v211, 0xffff0000, v242
    v_mul_f32 v210, v210, v240
    v_mul_f32 v211, v211, v240
    v_cvt_pk_bf16_f32 v33, v210, v211
    v_cvt_pk_bf16_f32 v242, v212, v213
    v_lshlrev_b32 v212, 16, v242
    v_and_b32 v213, 0xffff0000, v242
    v_mul_f32 v212, v212, v240
    v_mul_f32 v213, v213, v240
    v_cvt_pk_bf16_f32 v34, v212, v213
    v_cvt_pk_bf16_f32 v242, v214, v215
    v_lshlrev_b32 v214, 16, v242
    v_and_b32 v215, 0xffff0000, v242
    v_mul_f32 v214, v214, v240
    v_mul_f32 v215, v215, v240
    v_cvt_pk_bf16_f32 v35, v214, v215
    v_cvt_pk_bf16_f32 v242, v216, v217
    v_lshlrev_b32 v216, 16, v242
    v_and_b32 v217, 0xffff0000, v242
    v_mul_f32 v216, v216, v240
    v_mul_f32 v217, v217, v240
    v_cvt_pk_bf16_f32 v36, v216, v217
    v_cvt_pk_bf16_f32 v242, v218, v219
    v_lshlrev_b32 v218, 16, v242
    v_and_b32 v219, 0xffff0000, v242
    v_mul_f32 v218, v218, v240
    v_mul_f32 v219, v219, v240
    v_cvt_pk_bf16_f32 v37, v218, v219
    v_cvt_pk_bf16_f32 v242, v220, v221
    v_lshlrev_b32 v220, 16, v242
    v_and_b32 v221, 0xffff0000, v242
    v_mul_f32 v220, v220, v240
    v_mul_f32 v221, v221, v240
    v_cvt_pk_bf16_f32 v38, v220, v221
    v_cvt_pk_bf16_f32 v242, v222, v223
    v_lshlrev_b32 v222, 16, v242
    v_and_b32 v223, 0xffff0000, v242
    v_mul_f32 v222, v222, v240
    v_mul_f32 v223, v223, v240
    v_cvt_pk_bf16_f32 v39, v222, v223
    v_cmp_eq_u32 vcc, 0, v4
    s_nop 1
    v_cndmask_b32 v38, 0, v38, vcc
    v_cndmask_b32 v39, 0, v39, vcc
    ds_bpermute_b32 v240, v14, v236
    s_waitcnt lgkmcnt(0)
    v_cvt_pk_bf16_f32 v242, v240, v241
    v_lshlrev_b32 v240, 16, v242
    v_and_b32 v241, 0xffff0000, v242
    v_add_f32 v240, s91, v240
    v_cvt_pk_bf16_f32 v242, v240, v241
    v_lshlrev_b32 v240, 16, v242
    v_and_b32 v241, 0xffff0000, v242
    v_rcp_f32 v240, v240
    s_nop 0
    v_cvt_pk_bf16_f32 v242, v224, v225
    v_lshlrev_b32 v224, 16, v242
    v_and_b32 v225, 0xffff0000, v242
    v_mul_f32 v224, v224, v240
    v_mul_f32 v225, v225, v240
    v_cvt_pk_bf16_f32 v40, v224, v225
    v_cvt_pk_bf16_f32 v242, v226, v227
    v_lshlrev_b32 v226, 16, v242
    v_and_b32 v227, 0xffff0000, v242
    v_mul_f32 v226, v226, v240
    v_mul_f32 v227, v227, v240
    v_cvt_pk_bf16_f32 v41, v226, v227
    v_cvt_pk_bf16_f32 v242, v228, v229
    v_lshlrev_b32 v228, 16, v242
    v_and_b32 v229, 0xffff0000, v242
    v_mul_f32 v228, v228, v240
    v_mul_f32 v229, v229, v240
    v_cvt_pk_bf16_f32 v42, v228, v229
    v_cvt_pk_bf16_f32 v242, v230, v231
    v_lshlrev_b32 v230, 16, v242
    v_and_b32 v231, 0xffff0000, v242
    v_mul_f32 v230, v230, v240
    v_mul_f32 v231, v231, v240
    v_cvt_pk_bf16_f32 v43, v230, v231
    v_cvt_pk_bf16_f32 v242, v232, v233
    v_lshlrev_b32 v232, 16, v242
    v_and_b32 v233, 0xffff0000, v242
    v_mul_f32 v232, v232, v240
    v_mul_f32 v233, v233, v240
    v_cvt_pk_bf16_f32 v44, v232, v233
    v_cvt_pk_bf16_f32 v242, v234, v235
    v_lshlrev_b32 v234, 16, v242
    v_and_b32 v235, 0xffff0000, v242
    v_mul_f32 v234, v234, v240
    v_mul_f32 v235, v235, v240
    v_cvt_pk_bf16_f32 v45, v234, v235
    v_cvt_pk_bf16_f32 v242, v236, v237
    v_lshlrev_b32 v236, 16, v242
    v_and_b32 v237, 0xffff0000, v242
    v_mul_f32 v236, v236, v240
    v_mul_f32 v237, v237, v240
    v_cvt_pk_bf16_f32 v46, v236, v237
    v_cvt_pk_bf16_f32 v242, v238, v239
    v_lshlrev_b32 v238, 16, v242
    v_and_b32 v239, 0xffff0000, v242
    v_mul_f32 v238, v238, v240
    v_mul_f32 v239, v239, v240
    v_cvt_pk_bf16_f32 v47, v238, v239
    v_cmp_eq_u32 vcc, 0, v4
    s_nop 1
    v_cndmask_b32 v46, 0, v46, vcc
    v_cndmask_b32 v47, 0, v47, vcc
    s_add_u32 s30, s31, 14336
    s_mov_b32 m0, s30
    s_add_u32 s30, s32, 14336
    buffer_load_dwordx4 v7, s[24:27], s30 offen lds
    s_add_u32 s30, s31, 15360
    s_mov_b32 m0, s30
    s_add_u32 s30, s32, 15360
    buffer_load_dwordx4 v7, s[24:27], s30 offen lds
    s_movk_i32 s30, 7168
    buffer_load_dwordx4 v[184:187], v5, s[24:27], s30 offen
    buffer_load_dwordx4 v[188:191], v8, s[24:27], s30 offen
    s_waitcnt vmcnt(28)
    ds_read_b64_tr_b16 v[192:193], v6 offset:0
    ds_read_b64_tr_b16 v[194:195], v6 offset:256
    ds_read_b64_tr_b16 v[196:197], v6 offset:1024
    ds_read_b64_tr_b16 v[198:199], v6 offset:1280
    s_waitcnt lgkmcnt(0)
    v_mfma_f32_32x32x16_bf16 v[64:79], v[192:195], v[128:131], v[64:79]
    v_mfma_f32_32x32x16_bf16 v[80:95], v[192:195], v[132:135], v[80:95]
    v_mfma_f32_32x32x16_bf16 v[96:111], v[196:199], v[128:131], v[96:111]
    v_mfma_f32_32x32x16_bf16 v[112:127], v[196:199], v[132:135], v[112:127]
    s_add_u32 s30, s31, 0
    s_mov_b32 m0, s30
    s_add_u32 s30, s32, 16384
    buffer_load_dwordx4 v7, s[24:27], s30 offen lds
    s_add_u32 s30, s31, 1024
    s_mov_b32 m0, s30
    s_add_u32 s30, s32, 17408
    buffer_load_dwordx4 v7, s[24:27], s30 offen lds
    s_movk_i32 s30, 8192
    buffer_load_dwordx4 v[128:131], v5, s[24:27], s30 offen
    buffer_load_dwordx4 v[132:135], v8, s[24:27], s30 offen
    s_waitcnt vmcnt(28)
    ds_read_b64_tr_b16 v[192:193], v6 offset:2048
    ds_read_b64_tr_b16 v[194:195], v6 offset:2304
    ds_read_b64_tr_b16 v[196:197], v6 offset:3072
    ds_read_b64_tr_b16 v[198:199], v6 offset:3328
    s_waitcnt lgkmcnt(0)
    v_mfma_f32_32x32x16_bf16 v[64:79], v[192:195], v[136:139], v[64:79]
    v_mfma_f32_32x32x16_bf16 v[80:95], v[192:195], v[140:143], v[80:95]
    v_mfma_f32_32x32x16_bf16 v[96:111], v[196:199], v[136:139], v[96:111]
    v_mfma_f32_32x32x16_bf16 v[112:127], v[196:199], v[140:143], v[112:127]
    s_add_u32 s30, s31, 2048
    s_mov_b32 m0, s30
    s_add_u32 s30, s32, 18432
    buffer_load_dwordx4 v7, s[24:27], s30 offen lds
    s_add_u32 s30, s31, 3072
    s_mov_b32 m0, s30
    s_add_u32 s30, s32, 19456
    buffer_load_dwordx4 v7, s[24:27], s30 offen lds
    s_movk_i32 s30, 9216
    buffer_load_dwordx4 v[136:139], v5, s[24:27], s30 offen
    buffer_load_dwordx4 v[140:143], v8, s[24:27], s30 offen
    s_waitcnt vmcnt(28)
    ds_read_b64_tr_b16 v[192:193], v6 offset:4096
    ds_read_b64_tr_b16 v[194:195], v6 offset:4352
    ds_read_b64_tr_b16 v[196:197], v6 offset:5120
    ds_read_b64_tr_b16 v[198:199], v6 offset:5376
    s_waitcnt lgkmcnt(0)
    v_mfma_f32_32x32x16_bf16 v[64:79], v[192:195], v[144:147], v[64:79]
    v_mfma_f32_32x32x16_bf16 v[80:95], v[192:195], v[148:151], v[80:95]
    v_mfma_f32_32x32x16_bf16 v[96:111], v[196:199], v[144:147], v[96:111]
    v_mfma_f32_32x32x16_bf16 v[112:127], v[196:199], v[148:151], v[112:127]
    s_add_u32 s30, s31, 4096
    s_mov_b32 m0, s30
    s_add_u32 s30, s32, 20480
    buffer_load_dwordx4 v7, s[24:27], s30 offen lds
    s_add_u32 s30, s31, 5120
    s_mov_b32 m0, s30
    s_add_u32 s30, s32, 21504
    buffer_load_dwordx4 v7, s[24:27], s30 offen lds
    s_movk_i32 s30, 10240
    buffer_load_dwordx4 v[144:147], v5, s[24:27], s30 offen
    buffer_load_dwordx4 v[148:151], v8, s[24:27], s30 offen
    s_waitcnt vmcnt(28)
    ds_read_b64_tr_b16 v[192:193], v6 offset:6144
    ds_read_b64_tr_b16 v[194:195], v6 offset:6400
    ds_read_b64_tr_b16 v[196:197], v6 offset:7168
    ds_read_b64_tr_b16 v[198:199], v6 offset:7424
    s_waitcnt lgkmcnt(0)
    v_mfma_f32_32x32x16_bf16 v[64:79], v[192:195], v[152:155], v[64:79]
    v_mfma_f32_32x32x16_bf16 v[80:95], v[192:195], v[156:159], v[80:95]
    v_mfma_f32_32x32x16_bf16 v[96:111], v[196:199], v[152:155], v[96:111]
    v_mfma_f32_32x32x16_bf16 v[112:127], v[196:199], v[156:159], v[112:127]
    s_add_u32 s30, s31, 6144
    s_mov_b32 m0, s30
    s_add_u32 s30, s32, 22528
    buffer_load_dwordx4 v7, s[24:27], s30 offen lds
    s_add_u32 s30, s31, 7168
    s_mov_b32 m0, s30
    s_add_u32 s30, s32, 23552
    buffer_load_dwordx4 v7, s[24:27], s30 offen lds
    s_movk_i32 s30, 11264
    buffer_load_dwordx4 v[152:155], v5, s[24:27], s30 offen
    buffer_load_dwordx4 v[156:159], v8, s[24:27], s30 offen
    s_waitcnt vmcnt(28)
    ds_read_b64_tr_b16 v[192:193], v6 offset:8192
    ds_read_b64_tr_b16 v[194:195], v6 offset:8448
    ds_read_b64_tr_b16 v[196:197], v6 offset:9216
    ds_read_b64_tr_b16 v[198:199], v6 offset:9472
    s_waitcnt lgkmcnt(0)
    v_mfma_f32_32x32x16_bf16 v[64:79], v[192:195], v[160:163], v[64:79]
    v_mfma_f32_32x32x16_bf16 v[80:95], v[192:195], v[164:167], v[80:95]
    v_mfma_f32_32x32x16_bf16 v[96:111], v[196:199], v[160:163], v[96:111]
    v_mfma_f32_32x32x16_bf16 v[112:127], v[196:199], v[164:167], v[112:127]
    s_add_u32 s30, s31, 8192
    s_mov_b32 m0, s30
    s_add_u32 s30, s32, 24576
    buffer_load_dwordx4 v7, s[24:27], s30 offen lds
    s_add_u32 s30, s31, 9216
    s_mov_b32 m0, s30
    s_add_u32 s30, s32, 25600
    buffer_load_dwordx4 v7, s[24:27], s30 offen lds
    s_movk_i32 s30, 12288
    buffer_load_dwordx4 v[160:163], v5, s[24:27], s30 offen
    buffer_load_dwordx4 v[164:167], v8, s[24:27], s30 offen
    s_waitcnt vmcnt(28)
    ds_read_b64_tr_b16 v[192:193], v6 offset:10240
    ds_read_b64_tr_b16 v[194:195], v6 offset:10496
    ds_read_b64_tr_b16 v[196:197], v6 offset:11264
    ds_read_b64_tr_b16 v[198:199], v6 offset:11520
    s_waitcnt lgkmcnt(0)
    v_mfma_f32_32x32x16_bf16 v[64:79], v[192:195], v[168:171], v[64:79]
    v_mfma_f32_32x32x16_bf16 v[80:95], v[192:195], v[172:175], v[80:95]
    v_mfma_f32_32x32x16_bf16 v[96:111], v[196:199], v[168:171], v[96:111]
    v_mfma_f32_32x32x16_bf16 v[112:127], v[196:199], v[172:175], v[112:127]
    s_add_u32 s30, s31, 10240
    s_mov_b32 m0, s30
    s_add_u32 s30, s32, 26624
    buffer_load_dwordx4 v7, s[24:27], s30 offen lds
    s_add_u32 s30, s31, 11264
    s_mov_b32 m0, s30
    s_add_u32 s30, s32, 27648
    buffer_load_dwordx4 v7, s[24:27], s30 offen lds
    s_movk_i32 s30, 13312
    buffer_load_dwordx4 v[168:171], v5, s[24:27], s30 offen
    buffer_load_dwordx4 v[172:175], v8, s[24:27], s30 offen
    s_waitcnt vmcnt(28)
    ds_read_b64_tr_b16 v[192:193], v6 offset:12288
    ds_read_b64_tr_b16 v[194:195], v6 offset:12544
    ds_read_b64_tr_b16 v[196:197], v6 offset:13312
    ds_read_b64_tr_b16 v[198:199], v6 offset:13568
    s_waitcnt lgkmcnt(0)
    v_mfma_f32_32x32x16_bf16 v[64:79], v[192:195], v[176:179], v[64:79]
    v_mfma_f32_32x32x16_bf16 v[80:95], v[192:195], v[180:183], v[80:95]
    v_mfma_f32_32x32x16_bf16 v[96:111], v[196:199], v[176:179], v[96:111]
    v_mfma_f32_32x32x16_bf16 v[112:127], v[196:199], v[180:183], v[112:127]
    s_waitcnt vmcnt(24)
    ds_read_b64_tr_b16 v[192:193], v6 offset:14336
    ds_read_b64_tr_b16 v[194:195], v6 offset:14592
    ds_read_b64_tr_b16 v[196:197], v6 offset:15360
    ds_read_b64_tr_b16 v[198:199], v6 offset:15616
    s_waitcnt lgkmcnt(0)
    v_mfma_f32_32x32x16_bf16 v[64:79], v[192:195], v[184:187], v[64:79]
    v_mfma_f32_32x32x16_bf16 v[80:95], v[192:195], v[188:191], v[80:95]
    v_mfma_f32_32x32x16_bf16 v[96:111], v[196:199], v[184:187], v[96:111]
    v_mfma_f32_32x32x16_bf16 v[112:127], v[196:199], v[188:191], v[112:127]
    s_waitcnt vmcnt(20)
    ds_read_b64_tr_b16 v[192:193], v6 offset:0
    ds_read_b64_tr_b16 v[194:195], v6 offset:256
    ds_read_b64_tr_b16 v[196:197], v6 offset:1024
    ds_read_b64_tr_b16 v[198:199], v6 offset:1280
    s_waitcnt lgkmcnt(0)
    v_mfma_f32_32x32x16_bf16 v[64:79], v[192:195], v[128:131], v[64:79]
    v_mfma_f32_32x32x16_bf16 v[80:95], v[192:195], v[132:135], v[80:95]
    v_mfma_f32_32x32x16_bf16 v[96:111], v[196:199], v[128:131], v[96:111]
    v_mfma_f32_32x32x16_bf16 v[112:127], v[196:199], v[132:135], v[112:127]
    s_waitcnt vmcnt(16)
    ds_read_b64_tr_b16 v[192:193], v6 offset:2048
    ds_read_b64_tr_b16 v[194:195], v6 offset:2304
    ds_read_b64_tr_b16 v[196:197], v6 offset:3072
    ds_read_b64_tr_b16 v[198:199], v6 offset:3328
    s_waitcnt lgkmcnt(0)
    v_mfma_f32_32x32x16_bf16 v[64:79], v[192:195], v[136:139], v[64:79]
    v_mfma_f32_32x32x16_bf16 v[80:95], v[192:195], v[140:143], v[80:95]
    v_mfma_f32_32x32x16_bf16 v[96:111], v[196:199], v[136:139], v[96:111]
    v_mfma_f32_32x32x16_bf16 v[112:127], v[196:199], v[140:143], v[112:127]
    s_waitcnt vmcnt(12)
    ds_read_b64_tr_b16 v[192:193], v6 offset:4096
    ds_read_b64_tr_b16 v[194:195], v6 offset:4352
    ds_read_b64_tr_b16 v[196:197], v6 offset:5120
    ds_read_b64_tr_b16 v[198:199], v6 offset:5376
    s_waitcnt lgkmcnt(0)
    v_mfma_f32_32x32x16_bf16 v[64:79], v[192:195], v[144:147], v[64:79]
    v_mfma_f32_32x32x16_bf16 v[80:95], v[192:195], v[148:151], v[80:95]
    v_mfma_f32_32x32x16_bf16 v[96:111], v[196:199], v[144:147], v[96:111]
    v_mfma_f32_32x32x16_bf16 v[112:127], v[196:199], v[148:151], v[112:127]
    s_waitcnt vmcnt(8)
    ds_read_b64_tr_b16 v[192:193], v6 offset:6144
    ds_read_b64_tr_b16 v[194:195], v6 offset:6400
    ds_read_b64_tr_b16 v[196:197], v6 offset:7168
    ds_read_b64_tr_b16 v[198:199], v6 offset:7424
    s_waitcnt lgkmcnt(0)
    v_mfma_f32_32x32x16_bf16 v[64:79], v[192:195], v[152:155], v[64:79]
    v_mfma_f32_32x32x16_bf16 v[80:95], v[192:195], v[156:159], v[80:95]
    v_mfma_f32_32x32x16_bf16 v[96:111], v[196:199], v[152:155], v[96:111]
    v_mfma_f32_32x32x16_bf16 v[112:127], v[196:199], v[156:159], v[112:127]
    s_waitcnt vmcnt(4)
    ds_read_b64_tr_b16 v[192:193], v6 offset:8192
    ds_read_b64_tr_b16 v[194:195], v6 offset:8448
    ds_read_b64_tr_b16 v[196:197], v6 offset:9216
    ds_read_b64_tr_b16 v[198:199], v6 offset:9472
    s_waitcnt lgkmcnt(0)
    v_mfma_f32_32x32x16_bf16 v[64:79], v[192:195], v[160:163], v[64:79]
    v_mfma_f32_32x32x16_bf16 v[80:95], v[192:195], v[164:167], v[80:95]
    v_mfma_f32_32x32x16_bf16 v[96:111], v[196:199], v[160:163], v[96:111]
    v_mfma_f32_32x32x16_bf16 v[112:127], v[196:199], v[164:167], v[112:127]
    s_waitcnt vmcnt(0)
    ds_read_b64_tr_b16 v[192:193], v6 offset:10240
    ds_read_b64_tr_b16 v[194:195], v6 offset:10496
    ds_read_b64_tr_b16 v[196:197], v6 offset:11264
    ds_read_b64_tr_b16 v[198:199], v6 offset:11520
    s_waitcnt lgkmcnt(0)
    v_mfma_f32_32x32x16_bf16 v[64:79], v[192:195], v[168:171], v[64:79]
    v_mfma_f32_32x32x16_bf16 v[80:95], v[192:195], v[172:175], v[80:95]
    v_mfma_f32_32x32x16_bf16 v[96:111], v[196:199], v[168:171], v[96:111]
    v_mfma_f32_32x32x16_bf16 v[112:127], v[196:199], v[172:175], v[112:127]
    s_nop 15
    s_nop 3
    s_barrier
    v_lshlrev_b32 v10, 4, v1
    s_lshl_b32 s30, s6, 14
    v_add_u32 v10, s30, v10
    ds_write_b128 v10, v[64:67] offset:0
    ds_write_b128 v10, v[68:71] offset:1024
    ds_write_b128 v10, v[72:75] offset:2048
    ds_write_b128 v10, v[76:79] offset:3072
    ds_write_b128 v10, v[80:83] offset:4096
    ds_write_b128 v10, v[84:87] offset:5120
    ds_write_b128 v10, v[88:91] offset:6144
    ds_write_b128 v10, v[92:95] offset:7168
    ds_write_b128 v10, v[96:99] offset:8192
    ds_write_b128 v10, v[100:103] offset:9216
    ds_write_b128 v10, v[104:107] offset:10240
    ds_write_b128 v10, v[108:111] offset:11264
    ds_write_b128 v10, v[112:115] offset:12288
    ds_write_b128 v10, v[116:119] offset:13312
    ds_write_b128 v10, v[120:123] offset:14336
    ds_write_b128 v10, v[124:127] offset:15360
    s_waitcnt lgkmcnt(0)
    s_barrier
    v_lshlrev_b32 v10, 4, v1
    s_lshr_b32 s30, s6, 1
    s_lshl_b32 s30, s30, 12
    s_and_b32 s33, s6, 1
    s_lshl_b32 s33, s33, 11
    s_add_u32 s30, s30, s33
    v_add_u32 v10, s30, v10
    v_add_u32 v11, 0x10000, v10
    ds_read_b128 v[64:67], v10 offset:0
    ds_read_b128 v[68:71], v10 offset:1024
    ds_read_b128 v[72:75], v10 offset:16384
    ds_read_b128 v[76:79], v10 offset:17408
    ds_read_b128 v[80:83], v10 offset:32768
    ds_read_b128 v[84:87], v10 offset:33792
    ds_read_b128 v[88:91], v10 offset:49152
    ds_read_b128 v[92:95], v10 offset:50176
    ds_read_b128 v[96:99], v11 offset:0
    ds_read_b128 v[100:103], v11 offset:1024
    ds_read_b128 v[104:107], v11 offset:16384
    ds_read_b128 v[108:111], v11 offset:17408
    ds_read_b128 v[112:115], v11 offset:32768
    ds_read_b128 v[116:119], v11 offset:33792
    ds_read_b128 v[120:123], v11 offset:49152
    ds_read_b128 v[124:127], v11 offset:50176
    s_waitcnt lgkmcnt(0)
    v_add_f32 v64, v64, v72
    v_add_f32 v65, v65, v73
    v_add_f32 v66, v66, v74
    v_add_f32 v67, v67, v75
    v_add_f32 v68, v68, v76
    v_add_f32 v69, v69, v77
    v_add_f32 v70, v70, v78
    v_add_f32 v71, v71, v79
    v_add_f32 v64, v64, v80
    v_add_f32 v65, v65, v81
    v_add_f32 v66, v66, v82
    v_add_f32 v67, v67, v83
    v_add_f32 v68, v68, v84
    v_add_f32 v69, v69, v85
    v_add_f32 v70, v70, v86
    v_add_f32 v71, v71, v87
    v_add_f32 v64, v64, v88
    v_add_f32 v65, v65, v89
    v_add_f32 v66, v66, v90
    v_add_f32 v67, v67, v91
    v_add_f32 v68, v68, v92
    v_add_f32 v69, v69, v93
    v_add_f32 v70, v70, v94
    v_add_f32 v71, v71, v95
    v_add_f32 v64, v64, v96
    v_add_f32 v65, v65, v97
    v_add_f32 v66, v66, v98
    v_add_f32 v67, v67, v99
    v_add_f32 v68, v68, v100
    v_add_f32 v69, v69, v101
    v_add_f32 v70, v70, v102
    v_add_f32 v71, v71, v103
    v_add_f32 v64, v64, v104
    v_add_f32 v65, v65, v105
    v_add_f32 v66, v66, v106
    v_add_f32 v67, v67, v107
    v_add_f32 v68, v68, v108
    v_add_f32 v69, v69, v109
    v_add_f32 v70, v70, v110
    v_add_f32 v71, v71, v111
    v_add_f32 v64, v64, v112
    v_add_f32 v65, v65, v113
    v_add_f32 v66, v66, v114
    v_add_f32 v67, v67, v115
    v_add_f32 v68, v68, v116
    v_add_f32 v69, v69, v117
    v_add_f32 v70, v70, v118
    v_add_f32 v71, v71, v119
    v_add_f32 v64, v64, v120
    v_add_f32 v65, v65, v121
    v_add_f32 v66, v66, v122
    v_add_f32 v67, v67, v123
    v_add_f32 v68, v68, v124
    v_add_f32 v69, v69, v125
    v_add_f32 v70, v70, v126
    v_add_f32 v71, v71, v127
    v_cvt_pk_bf16_f32 v224, v64, v65
    v_lshlrev_b32 v64, 16, v224
    v_and_b32 v65, 0xffff0000, v224
    v_mul_f32 v224, s92, v64
    v_exp_f32 v224, v224
    s_nop 0
    v_add_f32 v224, 1.0, v224
    v_rcp_f32 v224, v224
    s_nop 0
    v_mul_f32 v64, v64, v224
    v_mul_f32 v225, s92, v65
    v_exp_f32 v225, v225
    s_nop 0
    v_add_f32 v225, 1.0, v225
    v_rcp_f32 v225, v225
    s_nop 0
    v_mul_f32 v65, v65, v225
    v_cvt_pk_bf16_f32 v224, v64, v65
    v_lshlrev_b32 v64, 16, v224
    v_and_b32 v65, 0xffff0000, v224
    v_cvt_pk_bf16_f32 v192, v64, v65
    v_cvt_pk_bf16_f32 v224, v66, v67
    v_lshlrev_b32 v66, 16, v224
    v_and_b32 v67, 0xffff0000, v224
    v_mul_f32 v224, s92, v66
    v_exp_f32 v224, v224
    s_nop 0
    v_add_f32 v224, 1.0, v224
    v_rcp_f32 v224, v224
    s_nop 0
    v_mul_f32 v66, v66, v224
    v_mul_f32 v225, s92, v67
    v_exp_f32 v225, v225
    s_nop 0
    v_add_f32 v225, 1.0, v225
    v_rcp_f32 v225, v225
    s_nop 0
    v_mul_f32 v67, v67, v225
    v_cvt_pk_bf16_f32 v224, v66, v67
    v_lshlrev_b32 v66, 16, v224
    v_and_b32 v67, 0xffff0000, v224
    v_cvt_pk_bf16_f32 v193, v66, v67
    v_cvt_pk_bf16_f32 v224, v68, v69
    v_lshlrev_b32 v68, 16, v224
    v_and_b32 v69, 0xffff0000, v224
    v_mul_f32 v224, s92, v68
    v_exp_f32 v224, v224
    s_nop 0
    v_add_f32 v224, 1.0, v224
    v_rcp_f32 v224, v224
    s_nop 0
    v_mul_f32 v68, v68, v224
    v_mul_f32 v225, s92, v69
    v_exp_f32 v225, v225
    s_nop 0
    v_add_f32 v225, 1.0, v225
    v_rcp_f32 v225, v225
    s_nop 0
    v_mul_f32 v69, v69, v225
    v_cvt_pk_bf16_f32 v224, v68, v69
    v_lshlrev_b32 v68, 16, v224
    v_and_b32 v69, 0xffff0000, v224
    v_cvt_pk_bf16_f32 v194, v68, v69
    v_cvt_pk_bf16_f32 v224, v70, v71
    v_lshlrev_b32 v70, 16, v224
    v_and_b32 v71, 0xffff0000, v224
    v_mul_f32 v224, s92, v70
    v_exp_f32 v224, v224
    s_nop 0
    v_add_f32 v224, 1.0, v224
    v_rcp_f32 v224, v224
    s_nop 0
    v_mul_f32 v70, v70, v224
    v_mul_f32 v225, s92, v71
    v_exp_f32 v225, v225
    s_nop 0
    v_add_f32 v225, 1.0, v225
    v_rcp_f32 v225, v225
    s_nop 0
    v_mul_f32 v71, v71, v225
    v_cvt_pk_bf16_f32 v224, v70, v71
    v_lshlrev_b32 v70, 16, v224
    v_and_b32 v71, 0xffff0000, v224
    v_cvt_pk_bf16_f32 v195, v70, v71
    v_mov_b32 v200, v192
    v_mov_b32 v201, v193
    v_mov_b32 v202, v194
    v_mov_b32 v203, v195
    s_bfe_u32 s30, s6, 0x10001
    s_lshl_b32 s30, s30, 5
    s_add_u32 s30, s30, s7
    v_add_u32 v13, s30, v3
    s_movk_i32 s30, 896
    v_mul_lo_u32 v13, v13, s30
    v_lshl_add_u32 v13, v4, 3, v13
    s_lshr_b32 s34, s6, 2
    s_lshl_b32 s34, s34, 6
    s_lshl_b32 s33, s5, 7
    s_add_u32 s34, s34, s33
    s_and_b32 s33, s6, 1
    s_lshl_b32 s33, s33, 5
    s_add_u32 s34, s34, s33
    buffer_load_dwordx2 v[204:205], v13, s[12:15], s34 offen
    buffer_load_dwordx2 v[206:207], v13, s[12:15], s34 offen offset:16
    s_barrier
    s_add_u32 s30, s31, 0
    s_mov_b32 m0, s30
    s_lshl_b32 s30, s5, 16
    s_lshl_b32 s33, s6, 12
    s_add_u32 s30, s30, s33
    s_add_u32 s30, s30, 25165824
    buffer_load_dwordx4 v7, s[24:27], s30 offen lds
    s_add_u32 s30, s31, 1024
    s_mov_b32 m0, s30
    s_lshl_b32 s30, s5, 16
    s_lshl_b32 s33, s6, 12
    s_add_u32 s30, s30, s33
    s_add_u32 s30, s30, 25166848
    buffer_load_dwordx4 v7, s[24:27], s30 offen lds
    s_add_u32 s30, s31, 2048
    s_mov_b32 m0, s30
    s_lshl_b32 s30, s5, 16
    s_lshl_b32 s33, s6, 12
    s_add_u32 s30, s30, s33
    s_add_u32 s30, s30, 25167872
    buffer_load_dwordx4 v7, s[24:27], s30 offen lds
    s_add_u32 s30, s31, 3072
    s_mov_b32 m0, s30
    s_lshl_b32 s30, s5, 16
    s_lshl_b32 s33, s6, 12
    s_add_u32 s30, s30, s33
    s_add_u32 s30, s30, 25168896
    buffer_load_dwordx4 v7, s[24:27], s30 offen lds
    s_add_u32 s30, s31, 4096
    s_mov_b32 m0, s30
    s_lshl_b32 s30, s5, 16
    s_lshl_b32 s33, s6, 12
    s_add_u32 s30, s30, s33
    s_add_u32 s30, s30, 25198592
    buffer_load_dwordx4 v7, s[24:27], s30 offen lds
    s_add_u32 s30, s31, 5120
    s_mov_b32 m0, s30
    s_lshl_b32 s30, s5, 16
    s_lshl_b32 s33, s6, 12
    s_add_u32 s30, s30, s33
    s_add_u32 s30, s30, 25199616
    buffer_load_dwordx4 v7, s[24:27], s30 offen lds
    s_add_u32 s30, s31, 6144
    s_mov_b32 m0, s30
    s_lshl_b32 s30, s5, 16
    s_lshl_b32 s33, s6, 12
    s_add_u32 s30, s30, s33
    s_add_u32 s30, s30, 25200640
    buffer_load_dwordx4 v7, s[24:27], s30 offen lds
    s_add_u32 s30, s31, 7168
    s_mov_b32 m0, s30
    s_lshl_b32 s30, s5, 16
    s_lshl_b32 s33, s6, 12
    s_add_u32 s30, s30, s33
    s_add_u32 s30, s30, 25201664
    buffer_load_dwordx4 v7, s[24:27], s30 offen lds
    v_mov_b32 v64, 0
    v_mov_b32 v65, 0
    v_mov_b32 v66, 0
    v_mov_b32 v67, 0
    v_mov_b32 v68, 0
    v_mov_b32 v69, 0
    v_mov_b32 v70, 0
    v_mov_b32 v71, 0
    v_mov_b32 v72, 0
    v_mov_b32 v73, 0
    v_mov_b32 v74, 0
    v_mov_b32 v75, 0
    v_mov_b32 v76, 0
    v_mov_b32 v77, 0
    v_mov_b32 v78, 0
    v_mov_b32 v79, 0
    v_mov_b32 v80, 0
    v_mov_b32 v81, 0
    v_mov_b32 v82, 0
    v_mov_b32 v83, 0
    v_mov_b32 v84, 0
    v_mov_b32 v85, 0
    v_mov_b32 v86, 0
    v_mov_b32 v87, 0
    v_mov_b32 v88, 0
    v_mov_b32 v89, 0
    v_mov_b32 v90, 0
    v_mov_b32 v91, 0
    v_mov_b32 v92, 0
    v_mov_b32 v93, 0
    v_mov_b32 v94, 0
    v_mov_b32 v95, 0
    v_mov_b32 v96, 0
    v_mov_b32 v97, 0
    v_mov_b32 v98, 0
    v_mov_b32 v99, 0
    v_mov_b32 v100, 0
    v_mov_b32 v101, 0
    v_mov_b32 v102, 0
    v_mov_b32 v103, 0
    v_mov_b32 v104, 0
    v_mov_b32 v105, 0
    v_mov_b32 v106, 0
    v_mov_b32 v107, 0
    v_mov_b32 v108, 0
    v_mov_b32 v109, 0
    v_mov_b32 v110, 0
    v_mov_b32 v111, 0
    v_mov_b32 v112, 0
    v_mov_b32 v113, 0
    v_mov_b32 v114, 0
    v_mov_b32 v115, 0
    v_mov_b32 v116, 0
    v_mov_b32 v117, 0
    v_mov_b32 v118, 0
    v_mov_b32 v119, 0
    v_mov_b32 v120, 0
    v_mov_b32 v121, 0
    v_mov_b32 v122, 0
    v_mov_b32 v123, 0
    v_mov_b32 v124, 0
    v_mov_b32 v125, 0
    v_mov_b32 v126, 0
    v_mov_b32 v127, 0
    s_waitcnt vmcnt(0)
    ds_read_b64_tr_b16 v[192:193], v6 offset:0
    ds_read_b64_tr_b16 v[194:195], v6 offset:256
    s_waitcnt lgkmcnt(0)
    v_mfma_f32_32x32x16_bf16 v[64:79], v[192:195], v[16:19], v[64:79]
    v_mfma_f32_32x32x16_bf16 v[80:95], v[192:195], v[32:35], v[80:95]
    s_nop 7
    ds_read_b64_tr_b16 v[192:193], v6 offset:4096
    ds_read_b64_tr_b16 v[194:195], v6 offset:4352
    s_waitcnt lgkmcnt(0)
    v_mfma_f32_32x32x16_bf16 v[96:111], v[192:195], v[16:19], v[96:111]
    v_mfma_f32_32x32x16_bf16 v[112:127], v[192:195], v[32:35], v[112:127]
    s_nop 7
    ds_read_b64_tr_b16 v[192:193], v6 offset:1024
    ds_read_b64_tr_b16 v[194:195], v6 offset:1280
    s_waitcnt lgkmcnt(0)
    v_mfma_f32_32x32x16_bf16 v[64:79], v[192:195], v[20:23], v[64:79]
    v_mfma_f32_32x32x16_bf16 v[80:95], v[192:195], v[36:39], v[80:95]
    s_nop 7
    ds_read_b64_tr_b16 v[192:193], v6 offset:5120
    ds_read_b64_tr_b16 v[194:195], v6 offset:5376
    s_waitcnt lgkmcnt(0)
    v_mfma_f32_32x32x16_bf16 v[96:111], v[192:195], v[20:23], v[96:111]
    v_mfma_f32_32x32x16_bf16 v[112:127], v[192:195], v[36:39], v[112:127]
    s_nop 7
    ds_read_b64_tr_b16 v[192:193], v6 offset:2048
    ds_read_b64_tr_b16 v[194:195], v6 offset:2304
    s_waitcnt lgkmcnt(0)
    v_mfma_f32_32x32x16_bf16 v[64:79], v[192:195], v[24:27], v[64:79]
    v_mfma_f32_32x32x16_bf16 v[80:95], v[192:195], v[40:43], v[80:95]
    s_nop 7
    ds_read_b64_tr_b16 v[192:193], v6 offset:6144
    ds_read_b64_tr_b16 v[194:195], v6 offset:6400
    s_waitcnt lgkmcnt(0)
    v_mfma_f32_32x32x16_bf16 v[96:111], v[192:195], v[24:27], v[96:111]
    v_mfma_f32_32x32x16_bf16 v[112:127], v[192:195], v[40:43], v[112:127]
    s_nop 7
    ds_read_b64_tr_b16 v[192:193], v6 offset:3072
    ds_read_b64_tr_b16 v[194:195], v6 offset:3328
    s_waitcnt lgkmcnt(0)
    v_mfma_f32_32x32x16_bf16 v[64:79], v[192:195], v[28:31], v[64:79]
    v_mfma_f32_32x32x16_bf16 v[80:95], v[192:195], v[44:47], v[80:95]
    s_nop 7
    ds_read_b64_tr_b16 v[192:193], v6 offset:7168
    ds_read_b64_tr_b16 v[194:195], v6 offset:7424
    s_waitcnt lgkmcnt(0)
    v_mfma_f32_32x32x16_bf16 v[96:111], v[192:195], v[28:31], v[96:111]
    v_mfma_f32_32x32x16_bf16 v[112:127], v[192:195], v[44:47], v[112:127]
    s_nop 7
    s_nop 15
    s_nop 3
    s_barrier
    v_lshlrev_b32 v10, 4, v1
    s_lshl_b32 s30, s6, 14
    v_add_u32 v10, s30, v10
    ds_write_b128 v10, v[64:67] offset:0
    ds_write_b128 v10, v[68:71] offset:1024
    ds_write_b128 v10, v[72:75] offset:2048
    ds_write_b128 v10, v[76:79] offset:3072
    ds_write_b128 v10, v[80:83] offset:4096
    ds_write_b128 v10, v[84:87] offset:5120
    ds_write_b128 v10, v[88:91] offset:6144
    ds_write_b128 v10, v[92:95] offset:7168
    ds_write_b128 v10, v[96:99] offset:8192
    ds_write_b128 v10, v[100:103] offset:9216
    ds_write_b128 v10, v[104:107] offset:10240
    ds_write_b128 v10, v[108:111] offset:11264
    ds_write_b128 v10, v[112:115] offset:12288
    ds_write_b128 v10, v[116:119] offset:13312
    ds_write_b128 v10, v[120:123] offset:14336
    ds_write_b128 v10, v[124:127] offset:15360
    s_waitcnt lgkmcnt(0)
    s_barrier
    v_lshlrev_b32 v10, 4, v1
    s_lshr_b32 s30, s6, 1
    s_lshl_b32 s30, s30, 12
    s_and_b32 s33, s6, 1
    s_lshl_b32 s33, s33, 11
    s_add_u32 s30, s30, s33
    v_add_u32 v10, s30, v10
    v_add_u32 v11, 0x10000, v10
    ds_read_b128 v[64:67], v10 offset:0
    ds_read_b128 v[68:71], v10 offset:1024
    ds_read_b128 v[72:75], v10 offset:16384
    ds_read_b128 v[76:79], v10 offset:17408
    ds_read_b128 v[80:83], v10 offset:32768
    ds_read_b128 v[84:87], v10 offset:33792
    ds_read_b128 v[88:91], v10 offset:49152
    ds_read_b128 v[92:95], v10 offset:50176
    ds_read_b128 v[96:99], v11 offset:0
    ds_read_b128 v[100:103], v11 offset:1024
    ds_read_b128 v[104:107], v11 offset:16384
    ds_read_b128 v[108:111], v11 offset:17408
    ds_read_b128 v[112:115], v11 offset:32768
    ds_read_b128 v[116:119], v11 offset:33792
    ds_read_b128 v[120:123], v11 offset:49152
    ds_read_b128 v[124:127], v11 offset:50176
    s_waitcnt lgkmcnt(0)
    v_add_f32 v64, v64, v72
    v_add_f32 v65, v65, v73
    v_add_f32 v66, v66, v74
    v_add_f32 v67, v67, v75
    v_add_f32 v68, v68, v76
    v_add_f32 v69, v69, v77
    v_add_f32 v70, v70, v78
    v_add_f32 v71, v71, v79
    v_add_f32 v64, v64, v80
    v_add_f32 v65, v65, v81
    v_add_f32 v66, v66, v82
    v_add_f32 v67, v67, v83
    v_add_f32 v68, v68, v84
    v_add_f32 v69, v69, v85
    v_add_f32 v70, v70, v86
    v_add_f32 v71, v71, v87
    v_add_f32 v64, v64, v88
    v_add_f32 v65, v65, v89
    v_add_f32 v66, v66, v90
    v_add_f32 v67, v67, v91
    v_add_f32 v68, v68, v92
    v_add_f32 v69, v69, v93
    v_add_f32 v70, v70, v94
    v_add_f32 v71, v71, v95
    v_add_f32 v64, v64, v96
    v_add_f32 v65, v65, v97
    v_add_f32 v66, v66, v98
    v_add_f32 v67, v67, v99
    v_add_f32 v68, v68, v100
    v_add_f32 v69, v69, v101
    v_add_f32 v70, v70, v102
    v_add_f32 v71, v71, v103
    v_add_f32 v64, v64, v104
    v_add_f32 v65, v65, v105
    v_add_f32 v66, v66, v106
    v_add_f32 v67, v67, v107
    v_add_f32 v68, v68, v108
    v_add_f32 v69, v69, v109
    v_add_f32 v70, v70, v110
    v_add_f32 v71, v71, v111
    v_add_f32 v64, v64, v112
    v_add_f32 v65, v65, v113
    v_add_f32 v66, v66, v114
    v_add_f32 v67, v67, v115
    v_add_f32 v68, v68, v116
    v_add_f32 v69, v69, v117
    v_add_f32 v70, v70, v118
    v_add_f32 v71, v71, v119
    v_add_f32 v64, v64, v120
    v_add_f32 v65, v65, v121
    v_add_f32 v66, v66, v122
    v_add_f32 v67, v67, v123
    v_add_f32 v68, v68, v124
    v_add_f32 v69, v69, v125
    v_add_f32 v70, v70, v126
    v_add_f32 v71, v71, v127
    v_cvt_pk_bf16_f32 v224, v64, v65
    v_lshlrev_b32 v64, 16, v224
    v_and_b32 v65, 0xffff0000, v224
    v_lshlrev_b32 v224, 16, v200
    v_and_b32 v225, 0xffff0000, v200
    v_mul_f32 v64, v64, v224
    v_mul_f32 v65, v65, v225
    v_cvt_pk_bf16_f32 v224, v64, v65
    v_lshlrev_b32 v64, 16, v224
    v_and_b32 v65, 0xffff0000, v224
    v_lshlrev_b32 v224, 16, v204
    v_and_b32 v225, 0xffff0000, v204
    v_add_f32 v64, v64, v224
    v_add_f32 v65, v65, v225
    v_cvt_pk_bf16_f32 v204, v64, v65
    v_cvt_pk_bf16_f32 v224, v66, v67
    v_lshlrev_b32 v66, 16, v224
    v_and_b32 v67, 0xffff0000, v224
    v_lshlrev_b32 v224, 16, v201
    v_and_b32 v225, 0xffff0000, v201
    v_mul_f32 v66, v66, v224
    v_mul_f32 v67, v67, v225
    v_cvt_pk_bf16_f32 v224, v66, v67
    v_lshlrev_b32 v66, 16, v224
    v_and_b32 v67, 0xffff0000, v224
    v_lshlrev_b32 v224, 16, v205
    v_and_b32 v225, 0xffff0000, v205
    v_add_f32 v66, v66, v224
    v_add_f32 v67, v67, v225
    v_cvt_pk_bf16_f32 v205, v66, v67
    v_cvt_pk_bf16_f32 v224, v68, v69
    v_lshlrev_b32 v68, 16, v224
    v_and_b32 v69, 0xffff0000, v224
    v_lshlrev_b32 v224, 16, v202
    v_and_b32 v225, 0xffff0000, v202
    v_mul_f32 v68, v68, v224
    v_mul_f32 v69, v69, v225
    v_cvt_pk_bf16_f32 v224, v68, v69
    v_lshlrev_b32 v68, 16, v224
    v_and_b32 v69, 0xffff0000, v224
    v_lshlrev_b32 v224, 16, v206
    v_and_b32 v225, 0xffff0000, v206
    v_add_f32 v68, v68, v224
    v_add_f32 v69, v69, v225
    v_cvt_pk_bf16_f32 v206, v68, v69
    v_cvt_pk_bf16_f32 v224, v70, v71
    v_lshlrev_b32 v70, 16, v224
    v_and_b32 v71, 0xffff0000, v224
    v_lshlrev_b32 v224, 16, v203
    v_and_b32 v225, 0xffff0000, v203
    v_mul_f32 v70, v70, v224
    v_mul_f32 v71, v71, v225
    v_cvt_pk_bf16_f32 v224, v70, v71
    v_lshlrev_b32 v70, 16, v224
    v_and_b32 v71, 0xffff0000, v224
    v_lshlrev_b32 v224, 16, v207
    v_and_b32 v225, 0xffff0000, v207
    v_add_f32 v70, v70, v224
    v_add_f32 v71, v71, v225
    v_cvt_pk_bf16_f32 v207, v70, v71
    buffer_store_dwordx2 v[204:205], v13, s[16:19], s34 offen
    buffer_store_dwordx2 v[206:207], v13, s[16:19], s34 offen offset:16
K2_done:
    s_endpgm
.section .rodata,"a"
.p2align 6
.amdhsa_kernel k0_kernel
  .amdhsa_next_free_vgpr 32
  .amdhsa_next_free_sgpr 100
  .amdhsa_accum_offset 32
  .amdhsa_group_segment_fixed_size 0
  .amdhsa_kernarg_size 80
  .amdhsa_user_sgpr_count 2
  .amdhsa_user_sgpr_kernarg_segment_ptr 1
  .amdhsa_system_sgpr_workgroup_id_x 1
.end_amdhsa_kernel
.section .rodata,"a"
.p2align 6
.amdhsa_kernel k1_kernel
  .amdhsa_next_free_vgpr 256
  .amdhsa_next_free_sgpr 100
  .amdhsa_accum_offset 256
  .amdhsa_group_segment_fixed_size 0
  .amdhsa_kernarg_size 80
  .amdhsa_user_sgpr_count 2
  .amdhsa_user_sgpr_kernarg_segment_ptr 1
  .amdhsa_system_sgpr_workgroup_id_x 1
.end_amdhsa_kernel
.section .rodata,"a"
.p2align 6
.amdhsa_kernel k2_kernel
  .amdhsa_next_free_vgpr 256
  .amdhsa_next_free_sgpr 100
  .amdhsa_accum_offset 256
  .amdhsa_group_segment_fixed_size 0
  .amdhsa_kernarg_size 80
  .amdhsa_user_sgpr_count 2
  .amdhsa_user_sgpr_kernarg_segment_ptr 1
  .amdhsa_system_sgpr_workgroup_id_x 1
.end_amdhsa_kernel
```
